```python
import torch

def _softmax(x, axis=-1):
    return torch.softmax(x, dim=axis)
def _gelu(x):
    return torch.nn.functional.gelu(x, approximate="tanh")
def _silu(x):
    return torch.nn.functional.silu(x)
def _sigmoid(x):
    return torch.sigmoid(x)
def _layernorm(x, axis=-1, eps=1e-5):
    m = x.mean(dim=axis, keepdim=True)
    v = x.var(dim=axis, keepdim=True, unbiased=False)
    return (x - m) / torch.sqrt(v + eps)
def _scatter_add(tgt, idx, src, axis=0):
    return tgt.clone().index_add_(axis, idx, src)
def _segment_sum(src, seg, n):
    out = torch.zeros((n,) + src.shape[1:], dtype=src.dtype)
    return out.index_add_(0, seg, src)
def _pad(x, pw):
    flat = tuple(v for pair in reversed(pw) for v in pair)
    return torch.nn.functional.pad(x, flat)

kernel_name = 'gated_mix__ssm_conv_h3__ssm_conv_s4d__prompt'

def setup_inputs():

    _w = (lambda a: (lambda t: t.to(torch.bfloat16) if t.is_floating_point() else t)(torch.as_tensor(a)))
    def _A_setup():
        B, S, D = 1, 2048, 640
        ks = 4
        return {
            "q": _w((lambda *s: torch.randn(*s, dtype=torch.bfloat16) * 0.05)(B, S, D)),
            "k": _w((lambda *s: torch.randn(*s, dtype=torch.bfloat16) * 0.4)(B, S, D)),
            "v": _w((lambda *s: torch.randn(*s, dtype=torch.bfloat16) * 0.2)(B, S, D)),
            "shift_k": _w((lambda *s: torch.randn(*s, dtype=torch.bfloat16) * 0.4)(D, ks) * 0.5),
            "ssm_k": _w((lambda *s: torch.randn(*s, dtype=torch.bfloat16) * 0.4)(D, S) * (1.0 / S ** 0.5)),
            "ssm_D": _w((lambda *s: torch.randn(*s, dtype=torch.bfloat16) * 0.2)(D)),
        }
    _A_in = _A_setup()

    def _B_setup():
        Bsz, L, D, N = 1, 2048, 640, 192
        return {
            "u": _w((lambda *s: torch.randn(*s, dtype=torch.bfloat16) * 0.05)(Bsz, L, D)),
            "log_A_real": _w((lambda *s: torch.randn(*s, dtype=torch.bfloat16) * 3.2)(D, N) * 0.5),
            "A_imag": _w((lambda *s: torch.randn(*s, dtype=torch.bfloat16) * 0.05)(D, N) * 3.14),
            "C_real": _w((lambda *s: torch.randn(*s, dtype=torch.bfloat16) * 0.1)(D, N) / N ** 0.5),
            "C_imag": _w((lambda *s: torch.randn(*s, dtype=torch.bfloat16) * 0.1)(D, N) / N ** 0.5),
            "log_dt": _w((lambda *s: torch.randn(*s, dtype=torch.bfloat16) * 0.05)(D) * 0.5 - 4.0),
            "D_skip": _w((lambda *s: torch.randn(*s, dtype=torch.bfloat16) * 0.05)(D)),
        }
    _B_in = _B_setup()

    return {
        "A_q": _A_in["q"],
        "A_k": _A_in["k"],
        "A_v": _A_in["v"],
        "A_shift_k": _A_in["shift_k"],
        "A_ssm_k": _A_in["ssm_k"],
        "A_ssm_D": _A_in["ssm_D"],
        "B_u": _B_in["u"],
        "B_log_A_real": _B_in["log_A_real"],
        "B_A_imag": _B_in["A_imag"],
        "B_C_real": _B_in["C_real"],
        "B_C_imag": _B_in["C_imag"],
        "B_log_dt": _B_in["log_dt"],
        "B_D_skip": _B_in["D_skip"],
        "gate_w": _w((lambda *s: torch.randn(*s, dtype=torch.bfloat16) * 0.05)(640) * 16.0),
    }

def reference(A_q, A_k, A_v, A_shift_k, A_ssm_k, A_ssm_D, B_u, B_log_A_real, B_A_imag, B_C_real, B_C_imag, B_log_dt, B_D_skip, gate_w):
    def _A_ref(q, k, v, shift_k, ssm_k, ssm_D):
        B, S, D = q.shape
        ks = shift_k.shape[-1]
        k_pad = _pad(k, ((0, 0), (ks - 1, 0), (0, 0)))
        k_shift = torch.zeros_like(k)
        for t in range(ks):
            k_shift = k_shift + k_pad[:, t:t + S, :] * shift_k[:, ks - 1 - t][None, None, :]
        kv = k_shift * v
        L = 2 * S
        kv_pad = _pad(kv, ((0, 0), (0, S), (0, 0)))
        kf_pad = _pad(ssm_k, ((0, 0), (0, S)))
        kv_f = (lambda x, axes=(-2,-1): torch.fft.rfft2(x.float(), dim=axes))(kv_pad[:, None, :, :], axes=(1, 2))
        kf_f = (lambda x, axes=(-2,-1): torch.fft.rfft2(x.float(), dim=axes))(kf_pad[:, None, :], axes=(1, 2))
        kf_f = (lambda x, *d: x.permute(*d))(kf_f, 1, 2, 0)
        y_f = kv_f * kf_f[None, :, :, :]
        y = (lambda x, s, axes=(-2,-1): torch.fft.irfft2(x, s=s, dim=axes).to(torch.bfloat16))(y_f, (1, L), axes=(1, 2))[:, 0, :S, :]
        y = y + kv * ssm_D[None, None, :]
        return q * y

    def _B_ref(u, log_A_real, A_imag, C_real, C_imag, log_dt, D_skip):
        L = u.shape[1]
        dt = torch.exp(log_dt)
        A = -torch.exp(log_A_real) + 1j * A_imag
        C = (C_real + 1j * C_imag) * dt[:, None]
        pos = (lambda x, dt: x.to(dt))(torch.arange(L), log_dt.dtype)
        P = torch.exp((A * dt[:, None])[:, :, None] * pos[None, None, :])
        K = 2.0 * torch.einsum("dn,dnl->dl", C, P).real
        L2 = 2 * L
        u_t = (lambda x, *d: x.permute(*d))(u, 0, 2, 1)
        Kf = (lambda x, *a, **k: torch.fft.rfft(x.float(), *a, **k))(K, L2)
        Uf = (lambda x, *a, **k: torch.fft.rfft(x.float(), *a, **k))(u_t, L2)
        y = (lambda x, *a, **k: torch.fft.irfft(x, *a, **k).to(torch.bfloat16))(Uf * Kf[None, :, :], L2)[:, :, :L]
        y = (lambda x, *d: x.permute(*d))(y, 0, 2, 1)
        return y + u * D_skip[None, None, :]

    x = A_q
    g = _sigmoid((x * gate_w).sum(-1, keepdims=True))
    a = _A_ref(x, A_k, A_v, A_shift_k, A_ssm_k, A_ssm_D)
    b = _B_ref(x, B_log_A_real, B_A_imag, B_C_real, B_C_imag, B_log_dt, B_D_skip)
    return g * a + (1 - g) * b
```

```asm
; @launch grid=(256,1,1) block=(512,1,1) lds=163840
.amdgcn_target "amdgcn-amd-amdhsa--gfx950"
    .text
    .globl gated_mix__ssm_conv_h3__ssm_conv_s4d__prompt_kernel
    .p2align 8
    .type gated_mix__ssm_conv_h3__ssm_conv_s4d__prompt_kernel,@function
gated_mix__ssm_conv_h3__ssm_conv_s4d__prompt_kernel:
    s_cmp_ge_u32 s2, 256
    s_cbranch_scc1 L_END
    s_load_dwordx8 s[36:43], s[0:1], 56
    s_load_dwordx2 s[44:45], s[0:1], 88
    s_load_dwordx4 s[4:7], s[0:1], 0
    s_load_dwordx4 s[8:11], s[0:1], 16
    s_load_dwordx2 s[12:13], s[0:1], 120
    s_load_dwordx2 s[64:65], s[0:1], 128
    s_load_dwordx2 s[46:47], s[0:1], 104
    s_load_dwordx4 s[48:51], s[0:1], 32
    s_load_dwordx2 s[52:53], s[0:1], 96
    s_load_dwordx2 s[54:55], s[0:1], 112
    v_lshrrev_b32 v1, 6, v0
    v_and_b32 v2, 63, v0
    v_readfirstlane_b32 s3, v1
    v_mov_b32 v3, 0
    v_mov_b32 v4, 163824
    ds_write_b32 v4, v3
    ds_write_b32 v4, v3 offset:4
    v_mov_b32 v5, 163808
    ds_write_b32 v5, v3
    ds_write_b32 v5, v3 offset:4
    ds_write_b32 v5, v3 offset:8
    ds_write_b32 v5, v3 offset:12
    s_lshr_b32 s19, s2, 5
    s_and_b32 s20, s2, 31
    s_mul_i32 s17, s19, 80
    s_lshr_b32 s21, s20, 1
    s_mul_i32 s21, s21, 5
    s_add_u32 s17, s17, s21
    s_and_b32 s18, s20, 1
    s_mul_i32 s21, s18, 3
    s_add_u32 s16, s17, s21
    s_add_u32 s17, s17, 2
    s_waitcnt lgkmcnt(0)
    s_barrier
    s_cmp_ge_u32 s3, 5
    s_cbranch_scc1 L_K
    s_setprio 3
    s_cmp_eq_u32 s3, 4
    s_cbranch_scc0 L_T1
    s_cmp_eq_u32 s2, 0
    s_cbranch_scc0 L_T1
    s_mov_b32 s40, s12
    s_and_b32 s41, s13, 0xffff
    s_mov_b32 s42, 256
    s_mov_b32 s43, 0x00020000
    s_memrealtime s[22:23]
    s_waitcnt lgkmcnt(0)
    s_or_b32 s22, s22, 1
    s_or_b32 s23, s23, 0x80000000
    v_mov_b32 v8, s22
    v_mov_b32 v9, s23
    v_mov_b32 v10, 0
    s_mov_b64 exec, 1
    buffer_store_dwordx2 v[8:9], v10, s[40:43], 0 offen sc1
    s_mov_b64 exec, -1
L_T1:
    s_mov_b32 s24, s4
    s_and_b32 s25, s5, 0xffff
    s_mov_b32 s26, 2621440
    s_mov_b32 s27, 0x00020000
    s_mov_b32 s28, s6
    s_and_b32 s29, s7, 0xffff
    s_mov_b32 s30, 2621440
    s_mov_b32 s31, 0x00020000
    s_mov_b32 s32, s8
    s_and_b32 s33, s9, 0xffff
    s_mov_b32 s34, 2621440
    s_mov_b32 s35, 0x00020000
    v_mul_u32_u24 v3, 205, v2
    v_lshrrev_b32 v3, 11, v3
    v_mul_u32_u24 v4, 10, v3
    v_sub_u32 v4, v2, v4
    v_mul_u32_u24 v3, 1280, v3
    v_lshl_add_u32 v3, v4, 4, v3
    s_mul_i32 s21, s20, 81920
    s_mul_i32 s22, s19, 160
    s_add_u32 s21, s21, s22
    v_add_u32 v3, s21, v3
    v_subrev_u32 v4, 3840, v3
    v_add_u32 v5, 1280, v3
    s_mov_b32 exec_hi, 0xff
    s_mov_b32 s15, s3
L_DMA_Q:
    s_mul_i32 s22, s15, 640
    s_lshr_b32 s23, s15, 1
    s_lshl_b32 s23, s23, 4
    s_add_u32 s22, s22, s23
    s_mul_i32 s14, s15, 5120
    s_sub_u32 s23, s14, 5120
    s_add_u32 m0, s22, 127488
    s_nop 0
    buffer_load_dwordx4 v3, s[24:27], s14 offen nt lds
    s_add_u32 s15, s15, 5
    s_cmp_le_u32 s15, 15
    s_cbranch_scc1 L_DMA_Q
    s_cmp_eq_u32 s3, 0
    s_cbranch_scc0 L_DMA
    s_mov_b32 m0, 148224
    s_nop 0
    buffer_load_dwordx4 v4, s[28:31], 0 offen nt lds
L_DMA:
    s_mov_b32 s15, s3
L_DMA_LOOP:
    s_mul_i32 s22, s15, 640
    s_lshr_b32 s23, s15, 1
    s_lshl_b32 s23, s23, 4
    s_add_u32 s22, s22, s23
    s_mul_i32 s14, s15, 5120
    s_sub_u32 s23, s14, 5120
    s_cmp_eq_u32 s15, 0
    s_cbranch_scc1 L_DMA_VQ
    s_add_u32 m0, s22, 148224
    s_nop 0
    buffer_load_dwordx4 v5, s[28:31], s23 offen nt lds
    s_cmp_eq_u32 s15, 16
    s_cbranch_scc1 L_DMA_DONE
L_DMA_VQ:
    s_add_u32 m0, s22, 137856
    s_nop 0
    buffer_load_dwordx4 v3, s[32:35], s14 offen nt lds
    s_add_u32 s15, s15, 5
    s_cmp_le_u32 s15, 16
    s_cbranch_scc1 L_DMA_LOOP
L_DMA_DONE:
    s_mov_b64 exec, -1
    s_mov_b32 s36, s10
    s_and_b32 s37, s11, 0xffff
    s_mov_b32 s38, 5120
    s_mov_b32 s39, 0x00020000
    s_mov_b32 s40, s46
    s_and_b32 s41, s47, 0xffff
    s_mov_b32 s42, 1280
    s_mov_b32 s43, 0x00020000
    v_lshrrev_b32 v11, 3, v0
    v_and_b32 v13, 7, v0
    s_mul_i32 s23, s19, 640
    v_lshl_add_u32 v12, v11, 4, s23
    buffer_load_dwordx4 v[16:19], v12, s[36:39], 0 offen
    s_and_b32 s23, s3, 3
    s_lshl_b32 s23, s23, 1
    s_lshl_b32 s14, s20, 6
    s_add_u32 s23, s23, s14
    s_lshl_b32 s14, s19, 3
    s_add_u32 s23, s23, s14
    v_lshrrev_b32 v12, 5, v2
    v_add_u32 v12, s23, v12
    v_and_b32 v14, 31, v2
    v_lshlrev_b32 v14, 4, v14
    v_mul_u32_u24 v15, 1280, v12
    v_add_u32 v15, v15, v14
    v_add_u32 v20, 1024, v15
    v_cmp_gt_u32 vcc, 256, v14
    v_mov_b32 v21, -1
    s_nop 0
    v_cndmask_b32 v20, v21, v20, vcc
    v_mul_u32_u24 v21, 1296, v13
    v_lshl_add_u32 v21, v11, 2, v21
    v_add_u32 v21, 127488, v21
    s_mul_i32 s23, s19, 80
    v_lshl_add_u32 v22, v11, 1, s23
    s_movk_i32 s14, 8448
    v_mul_lo_u32 v22, v22, s14
    s_lshl_b32 s15, s20, 7
    s_sub_u32 s15, 4080, s15
    v_lshlrev_b32 v23, 4, v13
    v_sub_u32 v23, s15, v23
    v_add_u32 v22, v22, v23
    s_add_u32 s44, s64, 0
    s_addc_u32 s45, s65, 0
    s_and_b32 s45, s45, 0xffff
    s_mov_b32 s46, 5406720
    s_mov_b32 s47, 0x00020000
    s_add_u32 s56, s64, 8388608
    s_addc_u32 s57, s65, 0
    s_and_b32 s57, s57, 0xffff
    s_mov_b32 s58, 2703360
    s_mov_b32 s59, 0x00020000
    v_lshrrev_b32 v3, 3, v2
    v_mul_u32_u24 v3, 4224, v3
    v_and_b32 v4, 7, v2
    v_lshl_add_u32 v3, v4, 4, v3
    s_mul_i32 s22, s19, 337920
    s_lshl_b32 s23, s20, 7
    s_add_u32 s22, s22, s23
    v_add_u32 v3, s22, v3
    v_mov_b32 v8, -1
    v_mov_b32 v9, -1
    v_mov_b32 v10, -1
    v_mov_b32 v11, -1
    s_mul_i32 s22, s3, 67584
    s_add_u32 s23, s22, 33792
    v_mov_b32 v26, 0
    s_cmp_eq_u32 s3, 4
    s_cbranch_scc0 L_NW4
    s_mov_b32 s40, s12
    s_and_b32 s41, s13, 0xffff
    s_mov_b32 s42, 256
    s_mov_b32 s43, 0x00020000
    buffer_load_dwordx2 v[24:25], v26, s[40:43], 0 offen sc1
L_NW4:
    s_waitcnt vmcnt(7)
    v_mov_b32 v4, 163824
    v_mov_b32 v5, 1
    s_mov_b64 exec, 1
    ds_add_u32 v4, v5
L_TSYNCQ:
    ds_read_b32 v5, v4
    s_waitcnt lgkmcnt(0)
    v_cmp_gt_u32 vcc, 5, v5
    s_nop 4
    s_cbranch_vccnz L_TSYNCQ
    s_mov_b64 exec, -1
    ds_read_b32 v68, v21 offset:0
    ds_read_b32 v69, v21 offset:160
    ds_read_b32 v70, v21 offset:320
    ds_read_b32 v71, v21 offset:480
    ds_read_b32 v72, v21 offset:640
    ds_read_b32 v73, v21 offset:800
    ds_read_b32 v74, v21 offset:960
    ds_read_b32 v75, v21 offset:1120
    s_mov_b32 s14, 0x05040100
    s_mov_b32 s15, 0x07060302
    s_waitcnt lgkmcnt(0)
    v_perm_b32 v148, v74, v75, s14
    v_perm_b32 v149, v72, v73, s14
    v_perm_b32 v150, v70, v71, s14
    v_perm_b32 v151, v68, v69, s14
    v_perm_b32 v156, v74, v75, s15
    v_perm_b32 v157, v72, v73, s15
    v_perm_b32 v158, v70, v71, s15
    v_perm_b32 v159, v68, v69, s15
    s_movk_i32 s14, 4224
    s_movk_i32 s15, 12672
    buffer_store_dwordx4 v[148:151], v22, s[44:47], s14 offen sc1
    buffer_store_dwordx4 v[156:159], v22, s[44:47], s15 offen sc1
    buffer_store_dwordx4 v[8:11], v3, s[56:59], s22 offen sc1
    buffer_store_dwordx4 v[8:11], v3, s[56:59], s23 offen sc1
    s_waitcnt vmcnt(4)
    s_cmp_eq_u32 s3, 4
    s_cbranch_scc0 L_TS0
    s_mov_b32 s21, 100000
L_NONCE_CHK:
    v_readfirstlane_b32 s66, v24
    v_readfirstlane_b32 s67, v25
    s_nop 1
    s_cmp_eq_u32 s66, 0
    s_cselect_b32 s14, 0, s67
    s_cmp_lg_u32 s14, 0
    s_cbranch_scc1 L_NONCE_OK
    s_sub_u32 s21, s21, 1
    s_cmp_eq_u32 s21, 0
    s_cbranch_scc1 L_NONCE_OK
    buffer_load_dwordx2 v[24:25], v26, s[40:43], 0 offen sc1
    s_waitcnt vmcnt(0)
    s_branch L_NONCE_CHK
L_NONCE_OK:
    v_mov_b32 v4, 163824
    s_mov_b64 exec, 1
    ds_write_b64 v4, v[24:25] offset:8
    s_mov_b64 exec, -1
L_TS0:
    v_mov_b32 v4, 163812
    v_mov_b32 v5, 1
    s_mov_b64 exec, 1
    ds_add_u32 v4, v5
L_TSYNCKV:
    ds_read_b32 v5, v4
    s_waitcnt lgkmcnt(0)
    v_cmp_gt_u32 vcc, 5, v5
    s_nop 4
    s_cbranch_vccnz L_TSYNCKV
    s_mov_b64 exec, -1
    s_cmp_eq_u32 s3, 4
    s_cbranch_scc1 L_NOG0
    buffer_load_dwordx4 v[24:27], v15, s[24:27], 0 offen
    buffer_load_dwordx4 v[28:31], v15, s[24:27], 0 offen offset:512
    buffer_load_dwordx4 v[32:35], v20, s[24:27], 0 offen
    buffer_load_dwordx4 v[36:39], v14, s[40:43], 0 offen
    buffer_load_dwordx4 v[40:43], v14, s[40:43], 0 offen offset:512
    buffer_load_dwordx4 v[44:47], v14, s[40:43], 0 offen offset:1024
L_NOG0:
    ds_read_b32 v48, v21 offset:20736
    ds_read_b32 v49, v21 offset:20896
    ds_read_b32 v50, v21 offset:21056
    ds_read_b32 v51, v21 offset:21216
    ds_read_b32 v52, v21 offset:21376
    ds_read_b32 v53, v21 offset:21536
    ds_read_b32 v54, v21 offset:21696
    ds_read_b32 v55, v21 offset:21856
    ds_read_b32 v56, v21 offset:22032
    ds_read_b32 v57, v21 offset:22192
    ds_read_b32 v58, v21 offset:22352
    ds_read_b32 v60, v21 offset:10368
    ds_read_b32 v61, v21 offset:10528
    ds_read_b32 v62, v21 offset:10688
    ds_read_b32 v63, v21 offset:10848
    ds_read_b32 v64, v21 offset:11008
    ds_read_b32 v65, v21 offset:11168
    ds_read_b32 v66, v21 offset:11328
    ds_read_b32 v67, v21 offset:11488
    v_lshlrev_b32 v80, 16, v16
    v_lshlrev_b32 v81, 16, v18
    v_and_b32 v82, 0xffff0000, v16
    v_and_b32 v83, 0xffff0000, v18
    v_lshlrev_b32 v84, 16, v17
    v_lshlrev_b32 v85, 16, v19
    v_and_b32 v86, 0xffff0000, v17
    v_and_b32 v87, 0xffff0000, v19
    s_waitcnt lgkmcnt(0)
    v_lshlrev_b32 v88, 16, v48
    v_and_b32 v89, 0xffff0000, v48
    v_lshlrev_b32 v90, 16, v49
    v_and_b32 v91, 0xffff0000, v49
    v_lshlrev_b32 v92, 16, v50
    v_and_b32 v93, 0xffff0000, v50
    v_lshlrev_b32 v94, 16, v51
    v_and_b32 v95, 0xffff0000, v51
    v_lshlrev_b32 v96, 16, v52
    v_and_b32 v97, 0xffff0000, v52
    v_lshlrev_b32 v98, 16, v53
    v_and_b32 v99, 0xffff0000, v53
    v_lshlrev_b32 v100, 16, v54
    v_and_b32 v101, 0xffff0000, v54
    v_lshlrev_b32 v102, 16, v55
    v_and_b32 v103, 0xffff0000, v55
    v_lshlrev_b32 v104, 16, v56
    v_and_b32 v105, 0xffff0000, v56
    v_lshlrev_b32 v106, 16, v57
    v_and_b32 v107, 0xffff0000, v57
    v_lshlrev_b32 v108, 16, v58
    v_and_b32 v109, 0xffff0000, v58
    v_lshlrev_b32 v110, 16, v60
    v_and_b32 v111, 0xffff0000, v60
    v_lshlrev_b32 v112, 16, v61
    v_and_b32 v113, 0xffff0000, v61
    v_lshlrev_b32 v114, 16, v62
    v_and_b32 v115, 0xffff0000, v62
    v_lshlrev_b32 v116, 16, v63
    v_and_b32 v117, 0xffff0000, v63
    v_lshlrev_b32 v118, 16, v64
    v_and_b32 v119, 0xffff0000, v64
    v_lshlrev_b32 v120, 16, v65
    v_and_b32 v121, 0xffff0000, v65
    v_lshlrev_b32 v122, 16, v66
    v_and_b32 v123, 0xffff0000, v66
    v_lshlrev_b32 v124, 16, v67
    v_and_b32 v125, 0xffff0000, v67
    v_pk_mul_f32 v[128:129], v[88:89], v[86:87]
    v_pk_mul_f32 v[130:131], v[90:91], v[86:87]
    v_pk_mul_f32 v[132:133], v[92:93], v[86:87]
    v_pk_mul_f32 v[134:135], v[94:95], v[86:87]
    v_pk_mul_f32 v[136:137], v[96:97], v[86:87]
    v_pk_mul_f32 v[138:139], v[98:99], v[86:87]
    v_pk_mul_f32 v[140:141], v[100:101], v[86:87]
    v_pk_mul_f32 v[142:143], v[102:103], v[86:87]
    v_pk_fma_f32 v[128:129], v[90:91], v[84:85], v[128:129]
    v_pk_fma_f32 v[130:131], v[92:93], v[84:85], v[130:131]
    v_pk_fma_f32 v[132:133], v[94:95], v[84:85], v[132:133]
    v_pk_fma_f32 v[134:135], v[96:97], v[84:85], v[134:135]
    v_pk_fma_f32 v[136:137], v[98:99], v[84:85], v[136:137]
    v_pk_fma_f32 v[138:139], v[100:101], v[84:85], v[138:139]
    v_pk_fma_f32 v[140:141], v[102:103], v[84:85], v[140:141]
    v_pk_fma_f32 v[142:143], v[104:105], v[84:85], v[142:143]
    v_pk_fma_f32 v[128:129], v[92:93], v[82:83], v[128:129]
    v_pk_fma_f32 v[130:131], v[94:95], v[82:83], v[130:131]
    v_pk_fma_f32 v[132:133], v[96:97], v[82:83], v[132:133]
    v_pk_fma_f32 v[134:135], v[98:99], v[82:83], v[134:135]
    v_pk_fma_f32 v[136:137], v[100:101], v[82:83], v[136:137]
    v_pk_fma_f32 v[138:139], v[102:103], v[82:83], v[138:139]
    v_pk_fma_f32 v[140:141], v[104:105], v[82:83], v[140:141]
    v_pk_fma_f32 v[142:143], v[106:107], v[82:83], v[142:143]
    v_pk_fma_f32 v[128:129], v[94:95], v[80:81], v[128:129]
    v_pk_fma_f32 v[130:131], v[96:97], v[80:81], v[130:131]
    v_pk_fma_f32 v[132:133], v[98:99], v[80:81], v[132:133]
    v_pk_fma_f32 v[134:135], v[100:101], v[80:81], v[134:135]
    v_pk_fma_f32 v[136:137], v[102:103], v[80:81], v[136:137]
    v_pk_fma_f32 v[138:139], v[104:105], v[80:81], v[138:139]
    v_pk_fma_f32 v[140:141], v[106:107], v[80:81], v[140:141]
    v_pk_fma_f32 v[142:143], v[108:109], v[80:81], v[142:143]
    v_pk_mul_f32 v[128:129], v[128:129], v[110:111]
    v_pk_mul_f32 v[130:131], v[130:131], v[112:113]
    v_pk_mul_f32 v[132:133], v[132:133], v[114:115]
    v_pk_mul_f32 v[134:135], v[134:135], v[116:117]
    v_pk_mul_f32 v[136:137], v[136:137], v[118:119]
    v_pk_mul_f32 v[138:139], v[138:139], v[120:121]
    v_pk_mul_f32 v[140:141], v[140:141], v[122:123]
    v_pk_mul_f32 v[142:143], v[142:143], v[124:125]
    v_cvt_pk_bf16_f32 v144, v142, v140
    v_cvt_pk_bf16_f32 v145, v138, v136
    v_cvt_pk_bf16_f32 v146, v134, v132
    v_cvt_pk_bf16_f32 v147, v130, v128
    v_cvt_pk_bf16_f32 v152, v143, v141
    v_cvt_pk_bf16_f32 v153, v139, v137
    v_cvt_pk_bf16_f32 v154, v135, v133
    v_cvt_pk_bf16_f32 v155, v131, v129
    s_movk_i32 s22, 8448
    buffer_store_dwordx4 v[144:147], v22, s[44:47], 0 offen sc1
    buffer_store_dwordx4 v[152:155], v22, s[44:47], s22 offen sc1
    s_and_b32 s14, s3, 1
    s_cmp_eq_u32 s14, 0
    s_cbranch_scc0 L_NOSSM
    s_lshr_b32 s22, s3, 1
    s_add_u32 s14, s16, s22
    s_cmp_eq_u32 s3, 4
    s_cselect_b32 s14, s17, s14
    s_lshl_b32 s23, s14, 12
    s_add_u32 s56, s48, s23
    s_addc_u32 s57, s49, 0
    s_and_b32 s57, s57, 0xffff
    s_mov_b32 s58, 4096
    s_mov_b32 s59, 0x00020000
    v_lshlrev_b32 v3, 4, v2
    s_mul_i32 s14, s3, 4608
    s_add_u32 m0, s14, 100320
    s_movk_i32 s23, 0
    buffer_load_dwordx4 v3, s[56:59], s23 offen nt lds
    s_add_u32 m0, s14, 101344
    s_movk_i32 s23, 1024
    buffer_load_dwordx4 v3, s[56:59], s23 offen nt lds
    s_add_u32 m0, s14, 102368
    s_movk_i32 s23, 2048
    buffer_load_dwordx4 v3, s[56:59], s23 offen nt lds
    s_add_u32 m0, s14, 103392
    s_movk_i32 s23, 3072
    buffer_load_dwordx4 v3, s[56:59], s23 offen nt lds
    s_cmp_eq_u32 s3, 4
    s_cbranch_scc1 L_XA4
    s_waitcnt vmcnt(4)
    s_branch L_XACK0
L_XA4:
    s_waitcnt vmcnt(4)
    s_branch L_XACK0
L_NOSSM:
    s_waitcnt vmcnt(0)
L_XACK0:
    s_cmp_eq_u32 s3, 4
    s_cbranch_scc1 L_W4D
    s_add_u32 s36, s64, 8060928
    s_addc_u32 s37, s65, 0
    s_and_b32 s37, s37, 0xffff
    s_mov_b32 s38, 16384
    s_mov_b32 s39, 0x00020000
    v_mov_b32 v4, 163824
    v_mov_b32 v5, 1
    s_mov_b64 exec, 1
    ds_add_u32 v4, v5 offset:4
    s_mov_b64 exec, -1
    v_mov_b32 v4, 0
    s_mov_b32 s14, 0x3f803f80
    v_lshlrev_b32 v48, 16, v24
    v_and_b32 v49, 0xffff0000, v24
    v_lshlrev_b32 v50, 16, v36
    v_and_b32 v51, 0xffff0000, v36
    v_pk_mul_f32 v[48:49], v[48:49], v[50:51]
    v_cvt_pk_bf16_f32 v48, v48, v49
    v_dot2_f32_bf16 v4, v48, s14, v4
    v_lshlrev_b32 v52, 16, v25
    v_and_b32 v53, 0xffff0000, v25
    v_lshlrev_b32 v54, 16, v37
    v_and_b32 v55, 0xffff0000, v37
    v_pk_mul_f32 v[52:53], v[52:53], v[54:55]
    v_cvt_pk_bf16_f32 v52, v52, v53
    v_dot2_f32_bf16 v4, v52, s14, v4
    v_lshlrev_b32 v48, 16, v26
    v_and_b32 v49, 0xffff0000, v26
    v_lshlrev_b32 v50, 16, v38
    v_and_b32 v51, 0xffff0000, v38
    v_pk_mul_f32 v[48:49], v[48:49], v[50:51]
    v_cvt_pk_bf16_f32 v48, v48, v49
    v_dot2_f32_bf16 v4, v48, s14, v4
    v_lshlrev_b32 v52, 16, v27
    v_and_b32 v53, 0xffff0000, v27
    v_lshlrev_b32 v54, 16, v39
    v_and_b32 v55, 0xffff0000, v39
    v_pk_mul_f32 v[52:53], v[52:53], v[54:55]
    v_cvt_pk_bf16_f32 v52, v52, v53
    v_dot2_f32_bf16 v4, v52, s14, v4
    v_lshlrev_b32 v48, 16, v28
    v_and_b32 v49, 0xffff0000, v28
    v_lshlrev_b32 v50, 16, v40
    v_and_b32 v51, 0xffff0000, v40
    v_pk_mul_f32 v[48:49], v[48:49], v[50:51]
    v_cvt_pk_bf16_f32 v48, v48, v49
    v_dot2_f32_bf16 v4, v48, s14, v4
    v_lshlrev_b32 v52, 16, v29
    v_and_b32 v53, 0xffff0000, v29
    v_lshlrev_b32 v54, 16, v41
    v_and_b32 v55, 0xffff0000, v41
    v_pk_mul_f32 v[52:53], v[52:53], v[54:55]
    v_cvt_pk_bf16_f32 v52, v52, v53
    v_dot2_f32_bf16 v4, v52, s14, v4
    v_lshlrev_b32 v48, 16, v30
    v_and_b32 v49, 0xffff0000, v30
    v_lshlrev_b32 v50, 16, v42
    v_and_b32 v51, 0xffff0000, v42
    v_pk_mul_f32 v[48:49], v[48:49], v[50:51]
    v_cvt_pk_bf16_f32 v48, v48, v49
    v_dot2_f32_bf16 v4, v48, s14, v4
    v_lshlrev_b32 v52, 16, v31
    v_and_b32 v53, 0xffff0000, v31
    v_lshlrev_b32 v54, 16, v43
    v_and_b32 v55, 0xffff0000, v43
    v_pk_mul_f32 v[52:53], v[52:53], v[54:55]
    v_cvt_pk_bf16_f32 v52, v52, v53
    v_dot2_f32_bf16 v4, v52, s14, v4
    v_lshlrev_b32 v48, 16, v32
    v_and_b32 v49, 0xffff0000, v32
    v_lshlrev_b32 v50, 16, v44
    v_and_b32 v51, 0xffff0000, v44
    v_pk_mul_f32 v[48:49], v[48:49], v[50:51]
    v_cvt_pk_bf16_f32 v48, v48, v49
    v_dot2_f32_bf16 v4, v48, s14, v4
    v_lshlrev_b32 v52, 16, v33
    v_and_b32 v53, 0xffff0000, v33
    v_lshlrev_b32 v54, 16, v45
    v_and_b32 v55, 0xffff0000, v45
    v_pk_mul_f32 v[52:53], v[52:53], v[54:55]
    v_cvt_pk_bf16_f32 v52, v52, v53
    v_dot2_f32_bf16 v4, v52, s14, v4
    v_lshlrev_b32 v48, 16, v34
    v_and_b32 v49, 0xffff0000, v34
    v_lshlrev_b32 v50, 16, v46
    v_and_b32 v51, 0xffff0000, v46
    v_pk_mul_f32 v[48:49], v[48:49], v[50:51]
    v_cvt_pk_bf16_f32 v48, v48, v49
    v_dot2_f32_bf16 v4, v48, s14, v4
    v_lshlrev_b32 v52, 16, v35
    v_and_b32 v53, 0xffff0000, v35
    v_lshlrev_b32 v54, 16, v47
    v_and_b32 v55, 0xffff0000, v47
    v_pk_mul_f32 v[52:53], v[52:53], v[54:55]
    v_cvt_pk_bf16_f32 v52, v52, v53
    v_dot2_f32_bf16 v4, v52, s14, v4
    s_nop 2
    v_add_f32_dpp v4, v4, v4 row_shr:1 row_mask:0xf bank_mask:0xf bound_ctrl:0
    s_nop 1
    v_add_f32_dpp v4, v4, v4 row_shr:2 row_mask:0xf bank_mask:0xf bound_ctrl:0
    s_nop 1
    v_add_f32_dpp v4, v4, v4 row_shr:4 row_mask:0xf bank_mask:0xf bound_ctrl:0
    s_nop 1
    v_add_f32_dpp v4, v4, v4 row_shr:8 row_mask:0xf bank_mask:0xf bound_ctrl:0
    s_nop 1
    v_add_f32_dpp v4, v4, v4 row_bcast:15 row_mask:0xa bank_mask:0xf
    v_cvt_pk_bf16_f32 v4, v4, v4
    v_lshlrev_b32 v4, 16, v4
    v_mul_f32 v5, 0xbfb8aa3b, v4
    v_exp_f32 v5, v5
    s_nop 0
    v_add_f32 v5, 1.0, v5
    v_rcp_f32 v5, v5
    s_nop 0
    v_cvt_pk_bf16_f32 v5, v5, v5
    v_lshlrev_b32 v5, 16, v5
    v_sub_f32 v6, 1.0, v5
    v_cvt_pk_bf16_f32 v6, v5, v6
    v_mov_b32 v9, 163824
    ds_read_b32 v7, v9 offset:8
    v_lshlrev_b32 v9, 3, v12
    v_and_b32 v8, 31, v2
    v_cmp_eq_u32 vcc, 31, v8
    s_waitcnt lgkmcnt(0)
    s_nop 1
    s_and_saveexec_b64 s[22:23], vcc
    buffer_store_dwordx2 v[6:7], v9, s[36:39], 0 offen sc1
    s_mov_b64 exec, -1
    s_branch L_PRE_B2
L_W4D:
    v_mov_b32 v4, 163824
    s_mov_b64 exec, 1
L_TSYNC2:
    ds_read_b32 v5, v4 offset:4
    s_waitcnt lgkmcnt(0)
    v_cmp_gt_u32 vcc, 4, v5
    s_nop 4
    s_cbranch_vccnz L_TSYNC2
    s_mov_b64 exec, -1
    s_mov_b32 s60, s64
    s_and_b32 s61, s65, 0xffff
    s_mov_b32 s62, 16777216
    s_mov_b32 s63, 0x00020000
    v_and_b32 v4, 63, v0
    v_lshl_add_u32 v4, v4, 3, s19
    v_lshlrev_b32 v4, 8, v4
    s_lshl_b32 s21, s20, 3
    s_add_u32 s21, s21, 13631488
    v_add_u32 v4, s21, v4
    v_mov_b32 v6, s66
    v_mov_b32 v7, s67
    s_mov_b64 exec, 0xffffffff
    buffer_store_dwordx2 v[6:7], v4, s[60:63], 0 offen sc1
    s_mov_b64 exec, -1
    v_and_b32 v4, 63, v0
    v_lshlrev_b32 v4, 3, v4
    s_lshl_b32 s21, s20, 3
    s_add_u32 s21, s21, s19
    s_lshl_b32 s21, s21, 8
    s_add_u32 s21, s21, 13631488
    v_add_u32 v4, s21, v4
    s_mov_b64 exec, 0xffffffff
    s_mov_b32 s21, 100000
    buffer_load_dwordx2 v[100:101], v4, s[60:63], 0 offen sc1
    s_sleep 8
    buffer_load_dwordx2 v[102:103], v4, s[60:63], 0 offen sc1
    s_sleep 8
    buffer_load_dwordx2 v[104:105], v4, s[60:63], 0 offen sc1
POLL_A:
    s_waitcnt vmcnt(2)
    v_cmp_ne_u32 vcc, s66, v100
    v_cmp_ne_u32 s[22:23], s67, v101
    s_nop 2
    s_or_b64 vcc, vcc, s[22:23]
    s_cbranch_vccz POLL_A_OK
    buffer_load_dwordx2 v[100:101], v4, s[60:63], 0 offen sc1
    s_waitcnt vmcnt(2)
    v_cmp_ne_u32 vcc, s66, v102
    v_cmp_ne_u32 s[22:23], s67, v103
    s_nop 2
    s_or_b64 vcc, vcc, s[22:23]
    s_cbranch_vccz POLL_A_OK
    buffer_load_dwordx2 v[102:103], v4, s[60:63], 0 offen sc1
    s_waitcnt vmcnt(2)
    v_cmp_ne_u32 vcc, s66, v104
    v_cmp_ne_u32 s[22:23], s67, v105
    s_nop 2
    s_or_b64 vcc, vcc, s[22:23]
    s_cbranch_vccz POLL_A_OK
    buffer_load_dwordx2 v[104:105], v4, s[60:63], 0 offen sc1
    s_sub_u32 s21, s21, 1
    s_cmp_eq_u32 s21, 0
    s_cbranch_scc0 POLL_A
POLL_A_OK:
    s_mov_b64 exec, -1
    s_branch L_PRE_B2
L_K:
    s_sub_u32 s22, s3, 5
    s_add_u32 s14, s16, s22
    s_cmp_eq_u32 s22, 2
    s_cselect_b32 s14, s17, s14
    s_mul_i32 s23, s14, 384
    v_lshl_add_u32 v6, v2, 1, s23
    s_lshl_b32 s23, s14, 1
    v_mov_b32 v7, s23
    s_mov_b32 s56, s44
    s_and_b32 s57, s45, 0xffff
    s_mov_b32 s58, 1280
    s_mov_b32 s59, 0x00020000
    buffer_load_ushort v164, v7, s[56:59], 0 offen
    s_mov_b32 s24, s36
    s_and_b32 s25, s37, 0xffff
    s_mov_b32 s26, 245760
    s_mov_b32 s27, 0x00020000
    buffer_load_ushort v152, v6, s[24:27], 0 offen offset:0
    buffer_load_ushort v156, v6, s[24:27], 0 offen offset:128
    buffer_load_ushort v160, v6, s[24:27], 0 offen offset:256
    s_mov_b32 s28, s38
    s_and_b32 s29, s39, 0xffff
    s_mov_b32 s30, 245760
    s_mov_b32 s31, 0x00020000
    buffer_load_ushort v153, v6, s[28:31], 0 offen offset:0
    buffer_load_ushort v157, v6, s[28:31], 0 offen offset:128
    buffer_load_ushort v161, v6, s[28:31], 0 offen offset:256
    s_mov_b32 s32, s40
    s_and_b32 s33, s41, 0xffff
    s_mov_b32 s34, 245760
    s_mov_b32 s35, 0x00020000
    buffer_load_ushort v154, v6, s[32:35], 0 offen offset:0
    buffer_load_ushort v158, v6, s[32:35], 0 offen offset:128
    buffer_load_ushort v162, v6, s[32:35], 0 offen offset:256
    s_mov_b32 s36, s42
    s_and_b32 s37, s43, 0xffff
    s_mov_b32 s38, 245760
    s_mov_b32 s39, 0x00020000
    buffer_load_ushort v155, v6, s[36:39], 0 offen offset:0
    buffer_load_ushort v159, v6, s[36:39], 0 offen offset:128
    buffer_load_ushort v163, v6, s[36:39], 0 offen offset:256
    s_mul_i32 s15, s22, 9216
    s_add_u32 s15, s15, 99840
    s_mul_i32 s21, s22, 13568
    v_lshlrev_b32 v7, 2, v2
    v_add_u32 v7, s21, v7
    v_xor_b32 v16, 0, v7
    v_xor_b32 v17, 16, v7
    v_xor_b32 v18, 32, v7
    v_xor_b32 v19, 48, v7
    v_xor_b32 v20, 64, v7
    v_xor_b32 v21, 80, v7
    v_xor_b32 v22, 96, v7
    v_xor_b32 v23, 112, v7
    v_xor_b32 v24, 128, v7
    v_xor_b32 v25, 144, v7
    v_xor_b32 v26, 160, v7
    v_xor_b32 v27, 176, v7
    v_xor_b32 v28, 192, v7
    v_xor_b32 v29, 208, v7
    v_xor_b32 v30, 224, v7
    v_xor_b32 v31, 240, v7
    v_and_b32 v8, 31, v2
    v_lshrrev_b32 v9, 5, v2
    v_min_u32 v10, 20, v8
    v_and_b32 v11, 15, v10
    v_xor_b32 v11, v11, v9
    v_lshlrev_b32 v11, 4, v11
    v_lshl_add_u32 v11, v10, 8, v11
    v_add_u32 v11, 8192, v11
    v_add_u32 v11, s21, v11
    v_xor_b32 v32, 0, v11
    v_xor_b32 v33, 32, v11
    v_xor_b32 v34, 64, v11
    v_xor_b32 v35, 96, v11
    v_xor_b32 v36, 128, v11
    v_xor_b32 v37, 160, v11
    v_xor_b32 v38, 192, v11
    v_xor_b32 v39, 224, v11
    v_and_b32 v11, 15, v8
    v_xor_b32 v11, v11, v9
    v_lshlrev_b32 v11, 4, v11
    v_lshl_add_u32 v11, v8, 8, v11
    v_add_u32 v11, s21, v11
    v_xor_b32 v40, 0, v11
    v_xor_b32 v41, 32, v11
    v_xor_b32 v42, 64, v11
    v_xor_b32 v43, 96, v11
    v_xor_b32 v44, 128, v11
    v_xor_b32 v45, 160, v11
    v_xor_b32 v46, 192, v11
    v_xor_b32 v47, 224, v11
    v_mov_b32 v8, 0
    v_mov_b32 v9, 0
    v_mov_b32 v10, 0
    v_mov_b32 v11, 0
    v_lshlrev_b32 v3, 4, v2
    v_add_u32 v6, s15, v3
    s_mov_b64 exec, 0x3fffffff
    ds_write_b128 v6, v[8:11]
    ds_write_b128 v6, v[8:11] offset:4608
    s_mov_b64 exec, -1
    v_mov_b32 v48, 0
    v_mov_b32 v49, 0
    v_mov_b32 v50, 0
    v_mov_b32 v51, 0
    v_mov_b32 v52, 0
    v_mov_b32 v53, 0
    v_mov_b32 v54, 0
    v_mov_b32 v55, 0
    v_mov_b32 v56, 0
    v_mov_b32 v57, 0
    v_mov_b32 v58, 0
    v_mov_b32 v59, 0
    v_mov_b32 v60, 0
    v_mov_b32 v61, 0
    v_mov_b32 v62, 0
    v_mov_b32 v63, 0
    s_waitcnt vmcnt(0)
    v_lshlrev_b32 v6, 16, v164
    v_mul_f32 v6, 0x3fb8aa3b, v6
    v_exp_f32 v6, v6
    s_nop 0
    v_cvt_pk_bf16_f32 v6, v6, v6
    v_lshlrev_b32 v6, 16, v6
    v_add_f32 v7, v6, v6
    v_lshlrev_b32 v8, 16, v152
    v_mul_f32 v8, 0x3fb8aa3b, v8
    v_exp_f32 v8, v8
    v_lshlrev_b32 v15, 16, v153
    v_mul_f32 v15, v15, v6
    v_mul_f32 v15, 0.15915494, v15
    v_cvt_pk_bf16_f32 v8, v8, v8
    v_lshlrev_b32 v8, 16, v8
    v_mul_f32 v14, v8, v6
    v_mul_f32 v14, 0xbfb8aa3b, v14
    v_lshlrev_b32 v80, 16, v154
    v_lshlrev_b32 v81, 16, v155
    v_mul_f32 v80, v80, v7
    v_mul_f32 v81, v81, v7
    v_exp_f32 v8, v14
    v_fract_f32 v9, v15
    v_cos_f32 v64, v9
    v_sin_f32 v65, v9
    v_mul_f32 v64, v8, v64
    v_mul_f32 v65, v8, v65
    v_mul_f32 v8, 0x41000000, v14
    v_mul_f32 v9, 0x41000000, v15
    v_exp_f32 v8, v8
    v_fract_f32 v9, v9
    v_cos_f32 v70, v9
    v_sin_f32 v71, v9
    v_mul_f32 v70, v8, v70
    v_mul_f32 v71, v8, v71
    v_mul_f32 v8, 0x43800000, v14
    v_mul_f32 v9, 0x43800000, v15
    v_exp_f32 v8, v8
    v_fract_f32 v9, v9
    v_cos_f32 v72, v9
    v_sin_f32 v73, v9
    v_mul_f32 v72, v8, v72
    v_mul_f32 v73, v8, v73
    v_mul_f32 v8, 0x43000000, v14
    v_mul_f32 v9, 0x43000000, v15
    v_exp_f32 v8, v8
    v_fract_f32 v9, v9
    v_cos_f32 v74, v9
    v_sin_f32 v75, v9
    v_mul_f32 v74, v8, v74
    v_mul_f32 v75, v8, v75
    v_pk_mul_f32 v[2:3], v[64:65], v[64:65] op_sel:[0,0] op_sel_hi:[1,0]
    v_pk_fma_f32 v[66:67], v[64:65], v[64:65], v[2:3] op_sel:[1,1,0] op_sel_hi:[0,1,1] neg_lo:[1,0,0]
    v_pk_mul_f32 v[2:3], v[66:67], v[66:67] op_sel:[0,0] op_sel_hi:[1,0]
    v_pk_fma_f32 v[68:69], v[66:67], v[66:67], v[2:3] op_sel:[1,1,0] op_sel_hi:[0,1,1] neg_lo:[1,0,0]
    v_pk_mul_f32 v[2:3], v[80:81], v[72:73] op_sel:[0,0] op_sel_hi:[1,0]
    v_pk_fma_f32 v[82:83], v[80:81], v[72:73], v[2:3] op_sel:[1,1,0] op_sel_hi:[0,1,1] neg_lo:[1,0,0]
    v_pk_mul_f32 v[2:3], v[82:83], v[72:73] op_sel:[0,0] op_sel_hi:[1,0]
    v_pk_fma_f32 v[84:85], v[82:83], v[72:73], v[2:3] op_sel:[1,1,0] op_sel_hi:[0,1,1] neg_lo:[1,0,0]
    v_pk_mul_f32 v[2:3], v[84:85], v[72:73] op_sel:[0,0] op_sel_hi:[1,0]
    v_pk_fma_f32 v[86:87], v[84:85], v[72:73], v[2:3] op_sel:[1,1,0] op_sel_hi:[0,1,1] neg_lo:[1,0,0]
    v_mov_b32 v152, v156
    v_mov_b32 v153, v157
    v_mov_b32 v154, v158
    v_mov_b32 v155, v159
    v_mov_b32 v156, v160
    v_mov_b32 v157, v161
    v_mov_b32 v158, v162
    v_mov_b32 v159, v163
    s_mov_b32 s23, 3
L_GEN:
    v_mov_b32 v76, 1.0
    v_mov_b32 v77, 0
    v_cvt_pk_bf16_f32 v8, v76, v77
    v_cvt_pk_bf16_f32 v9, v74, v75
    v_pk_mul_f32 v[2:3], v[74:75], v[70:71] op_sel:[0,0] op_sel_hi:[1,0]
    v_pk_fma_f32 v[78:79], v[74:75], v[70:71], v[2:3] op_sel:[1,1,0] op_sel_hi:[0,1,1] neg_lo:[1,0,0]
    v_cvt_pk_bf16_f32 v10, v70, v71
    v_cvt_pk_bf16_f32 v11, v78, v79
    v_pk_mul_f32 v[2:3], v[70:71], v[70:71] op_sel:[0,0] op_sel_hi:[1,0]
    v_pk_fma_f32 v[76:77], v[70:71], v[70:71], v[2:3] op_sel:[1,1,0] op_sel_hi:[0,1,1] neg_lo:[1,0,0]
    v_pk_mul_f32 v[4:5], v[78:79], v[70:71] op_sel:[0,0] op_sel_hi:[1,0]
    v_pk_fma_f32 v[78:79], v[78:79], v[70:71], v[4:5] op_sel:[1,1,0] op_sel_hi:[0,1,1] neg_lo:[1,0,0]
    v_cvt_pk_bf16_f32 v12, v76, v77
    v_cvt_pk_bf16_f32 v13, v78, v79
    ds_write2st64_b32 v16, v8, v9 offset0:0 offset1:16
    v_pk_mul_f32 v[2:3], v[76:77], v[70:71] op_sel:[0,0] op_sel_hi:[1,0]
    v_pk_fma_f32 v[76:77], v[76:77], v[70:71], v[2:3] op_sel:[1,1,0] op_sel_hi:[0,1,1] neg_lo:[1,0,0]
    v_pk_mul_f32 v[4:5], v[78:79], v[70:71] op_sel:[0,0] op_sel_hi:[1,0]
    v_pk_fma_f32 v[78:79], v[78:79], v[70:71], v[4:5] op_sel:[1,1,0] op_sel_hi:[0,1,1] neg_lo:[1,0,0]
    v_cvt_pk_bf16_f32 v8, v76, v77
    v_cvt_pk_bf16_f32 v9, v78, v79
    ds_write2st64_b32 v17, v10, v11 offset0:1 offset1:17
    v_pk_mul_f32 v[2:3], v[76:77], v[70:71] op_sel:[0,0] op_sel_hi:[1,0]
    v_pk_fma_f32 v[76:77], v[76:77], v[70:71], v[2:3] op_sel:[1,1,0] op_sel_hi:[0,1,1] neg_lo:[1,0,0]
    v_pk_mul_f32 v[4:5], v[78:79], v[70:71] op_sel:[0,0] op_sel_hi:[1,0]
    v_pk_fma_f32 v[78:79], v[78:79], v[70:71], v[4:5] op_sel:[1,1,0] op_sel_hi:[0,1,1] neg_lo:[1,0,0]
    v_cvt_pk_bf16_f32 v10, v76, v77
    v_cvt_pk_bf16_f32 v11, v78, v79
    ds_write2st64_b32 v18, v12, v13 offset0:2 offset1:18
    v_pk_mul_f32 v[2:3], v[76:77], v[70:71] op_sel:[0,0] op_sel_hi:[1,0]
    v_pk_fma_f32 v[76:77], v[76:77], v[70:71], v[2:3] op_sel:[1,1,0] op_sel_hi:[0,1,1] neg_lo:[1,0,0]
    v_pk_mul_f32 v[4:5], v[78:79], v[70:71] op_sel:[0,0] op_sel_hi:[1,0]
    v_pk_fma_f32 v[78:79], v[78:79], v[70:71], v[4:5] op_sel:[1,1,0] op_sel_hi:[0,1,1] neg_lo:[1,0,0]
    v_cvt_pk_bf16_f32 v12, v76, v77
    v_cvt_pk_bf16_f32 v13, v78, v79
    ds_write2st64_b32 v19, v8, v9 offset0:3 offset1:19
    v_pk_mul_f32 v[2:3], v[76:77], v[70:71] op_sel:[0,0] op_sel_hi:[1,0]
    v_pk_fma_f32 v[76:77], v[76:77], v[70:71], v[2:3] op_sel:[1,1,0] op_sel_hi:[0,1,1] neg_lo:[1,0,0]
    v_pk_mul_f32 v[4:5], v[78:79], v[70:71] op_sel:[0,0] op_sel_hi:[1,0]
    v_pk_fma_f32 v[78:79], v[78:79], v[70:71], v[4:5] op_sel:[1,1,0] op_sel_hi:[0,1,1] neg_lo:[1,0,0]
    v_cvt_pk_bf16_f32 v8, v76, v77
    v_cvt_pk_bf16_f32 v9, v78, v79
    ds_write2st64_b32 v20, v10, v11 offset0:4 offset1:20
    v_pk_mul_f32 v[2:3], v[76:77], v[70:71] op_sel:[0,0] op_sel_hi:[1,0]
    v_pk_fma_f32 v[76:77], v[76:77], v[70:71], v[2:3] op_sel:[1,1,0] op_sel_hi:[0,1,1] neg_lo:[1,0,0]
    v_pk_mul_f32 v[4:5], v[78:79], v[70:71] op_sel:[0,0] op_sel_hi:[1,0]
    v_pk_fma_f32 v[78:79], v[78:79], v[70:71], v[4:5] op_sel:[1,1,0] op_sel_hi:[0,1,1] neg_lo:[1,0,0]
    v_cvt_pk_bf16_f32 v10, v76, v77
    v_cvt_pk_bf16_f32 v11, v78, v79
    ds_write2st64_b32 v21, v12, v13 offset0:5 offset1:21
    v_pk_mul_f32 v[2:3], v[76:77], v[70:71] op_sel:[0,0] op_sel_hi:[1,0]
    v_pk_fma_f32 v[76:77], v[76:77], v[70:71], v[2:3] op_sel:[1,1,0] op_sel_hi:[0,1,1] neg_lo:[1,0,0]
    v_pk_mul_f32 v[4:5], v[78:79], v[70:71] op_sel:[0,0] op_sel_hi:[1,0]
    v_pk_fma_f32 v[78:79], v[78:79], v[70:71], v[4:5] op_sel:[1,1,0] op_sel_hi:[0,1,1] neg_lo:[1,0,0]
    v_cvt_pk_bf16_f32 v12, v76, v77
    v_cvt_pk_bf16_f32 v13, v78, v79
    ds_write2st64_b32 v22, v8, v9 offset0:6 offset1:22
    v_pk_mul_f32 v[2:3], v[76:77], v[70:71] op_sel:[0,0] op_sel_hi:[1,0]
    v_pk_fma_f32 v[76:77], v[76:77], v[70:71], v[2:3] op_sel:[1,1,0] op_sel_hi:[0,1,1] neg_lo:[1,0,0]
    v_pk_mul_f32 v[4:5], v[78:79], v[70:71] op_sel:[0,0] op_sel_hi:[1,0]
    v_pk_fma_f32 v[78:79], v[78:79], v[70:71], v[4:5] op_sel:[1,1,0] op_sel_hi:[0,1,1] neg_lo:[1,0,0]
    v_cvt_pk_bf16_f32 v8, v76, v77
    v_cvt_pk_bf16_f32 v9, v78, v79
    ds_write2st64_b32 v23, v10, v11 offset0:7 offset1:23
    v_pk_mul_f32 v[2:3], v[76:77], v[70:71] op_sel:[0,0] op_sel_hi:[1,0]
    v_pk_fma_f32 v[76:77], v[76:77], v[70:71], v[2:3] op_sel:[1,1,0] op_sel_hi:[0,1,1] neg_lo:[1,0,0]
    v_pk_mul_f32 v[4:5], v[78:79], v[70:71] op_sel:[0,0] op_sel_hi:[1,0]
    v_pk_fma_f32 v[78:79], v[78:79], v[70:71], v[4:5] op_sel:[1,1,0] op_sel_hi:[0,1,1] neg_lo:[1,0,0]
    v_cvt_pk_bf16_f32 v10, v76, v77
    v_cvt_pk_bf16_f32 v11, v78, v79
    ds_write2st64_b32 v24, v12, v13 offset0:8 offset1:24
    v_pk_mul_f32 v[2:3], v[76:77], v[70:71] op_sel:[0,0] op_sel_hi:[1,0]
    v_pk_fma_f32 v[76:77], v[76:77], v[70:71], v[2:3] op_sel:[1,1,0] op_sel_hi:[0,1,1] neg_lo:[1,0,0]
    v_pk_mul_f32 v[4:5], v[78:79], v[70:71] op_sel:[0,0] op_sel_hi:[1,0]
    v_pk_fma_f32 v[78:79], v[78:79], v[70:71], v[4:5] op_sel:[1,1,0] op_sel_hi:[0,1,1] neg_lo:[1,0,0]
    v_cvt_pk_bf16_f32 v12, v76, v77
    v_cvt_pk_bf16_f32 v13, v78, v79
    ds_write2st64_b32 v25, v8, v9 offset0:9 offset1:25
    v_pk_mul_f32 v[2:3], v[76:77], v[70:71] op_sel:[0,0] op_sel_hi:[1,0]
    v_pk_fma_f32 v[76:77], v[76:77], v[70:71], v[2:3] op_sel:[1,1,0] op_sel_hi:[0,1,1] neg_lo:[1,0,0]
    v_pk_mul_f32 v[4:5], v[78:79], v[70:71] op_sel:[0,0] op_sel_hi:[1,0]
    v_pk_fma_f32 v[78:79], v[78:79], v[70:71], v[4:5] op_sel:[1,1,0] op_sel_hi:[0,1,1] neg_lo:[1,0,0]
    v_cvt_pk_bf16_f32 v8, v76, v77
    v_cvt_pk_bf16_f32 v9, v78, v79
    ds_write2st64_b32 v26, v10, v11 offset0:10 offset1:26
    v_pk_mul_f32 v[2:3], v[76:77], v[70:71] op_sel:[0,0] op_sel_hi:[1,0]
    v_pk_fma_f32 v[76:77], v[76:77], v[70:71], v[2:3] op_sel:[1,1,0] op_sel_hi:[0,1,1] neg_lo:[1,0,0]
    v_pk_mul_f32 v[4:5], v[78:79], v[70:71] op_sel:[0,0] op_sel_hi:[1,0]
    v_pk_fma_f32 v[78:79], v[78:79], v[70:71], v[4:5] op_sel:[1,1,0] op_sel_hi:[0,1,1] neg_lo:[1,0,0]
    v_cvt_pk_bf16_f32 v10, v76, v77
    v_cvt_pk_bf16_f32 v11, v78, v79
    ds_write2st64_b32 v27, v12, v13 offset0:11 offset1:27
    v_pk_mul_f32 v[2:3], v[76:77], v[70:71] op_sel:[0,0] op_sel_hi:[1,0]
    v_pk_fma_f32 v[76:77], v[76:77], v[70:71], v[2:3] op_sel:[1,1,0] op_sel_hi:[0,1,1] neg_lo:[1,0,0]
    v_pk_mul_f32 v[4:5], v[78:79], v[70:71] op_sel:[0,0] op_sel_hi:[1,0]
    v_pk_fma_f32 v[78:79], v[78:79], v[70:71], v[4:5] op_sel:[1,1,0] op_sel_hi:[0,1,1] neg_lo:[1,0,0]
    v_cvt_pk_bf16_f32 v12, v76, v77
    v_cvt_pk_bf16_f32 v13, v78, v79
    ds_write2st64_b32 v28, v8, v9 offset0:12 offset1:28
    v_pk_mul_f32 v[2:3], v[76:77], v[70:71] op_sel:[0,0] op_sel_hi:[1,0]
    v_pk_fma_f32 v[76:77], v[76:77], v[70:71], v[2:3] op_sel:[1,1,0] op_sel_hi:[0,1,1] neg_lo:[1,0,0]
    v_pk_mul_f32 v[4:5], v[78:79], v[70:71] op_sel:[0,0] op_sel_hi:[1,0]
    v_pk_fma_f32 v[78:79], v[78:79], v[70:71], v[4:5] op_sel:[1,1,0] op_sel_hi:[0,1,1] neg_lo:[1,0,0]
    v_cvt_pk_bf16_f32 v8, v76, v77
    v_cvt_pk_bf16_f32 v9, v78, v79
    ds_write2st64_b32 v29, v10, v11 offset0:13 offset1:29
    v_pk_mul_f32 v[2:3], v[82:83], v[66:67] op_sel:[0,0] op_sel_hi:[1,0]
    v_pk_fma_f32 v[76:77], v[82:83], v[66:67], v[2:3] op_sel:[1,1,0] op_sel_hi:[0,1,1] neg_lo:[1,0,0]
    v_cvt_pk_bf16_f32 v10, v80, -v81
    v_cvt_pk_bf16_f32 v11, v76, -v77
    ds_write2st64_b32 v30, v12, v13 offset0:14 offset1:30
    v_pk_mul_f32 v[2:3], v[80:81], v[64:65] op_sel:[0,0] op_sel_hi:[1,0]
    v_pk_fma_f32 v[78:79], v[80:81], v[64:65], v[2:3] op_sel:[1,1,0] op_sel_hi:[0,1,1] neg_lo:[1,0,0]
    v_pk_mul_f32 v[4:5], v[76:77], v[66:67] op_sel:[0,0] op_sel_hi:[1,0]
    v_pk_fma_f32 v[76:77], v[76:77], v[66:67], v[4:5] op_sel:[1,1,0] op_sel_hi:[0,1,1] neg_lo:[1,0,0]
    v_cvt_pk_bf16_f32 v12, v78, -v79
    v_cvt_pk_bf16_f32 v13, v76, -v77
    ds_write2st64_b32 v31, v8, v9 offset0:15 offset1:31
    v_pk_mul_f32 v[2:3], v[78:79], v[64:65] op_sel:[0,0] op_sel_hi:[1,0]
    v_pk_fma_f32 v[78:79], v[78:79], v[64:65], v[2:3] op_sel:[1,1,0] op_sel_hi:[0,1,1] neg_lo:[1,0,0]
    v_pk_mul_f32 v[4:5], v[76:77], v[66:67] op_sel:[0,0] op_sel_hi:[1,0]
    v_pk_fma_f32 v[76:77], v[76:77], v[66:67], v[4:5] op_sel:[1,1,0] op_sel_hi:[0,1,1] neg_lo:[1,0,0]
    v_cvt_pk_bf16_f32 v8, v78, -v79
    v_cvt_pk_bf16_f32 v9, v76, -v77
    ds_write2st64_b32 v16, v10, v11 offset0:32 offset1:48
    v_pk_mul_f32 v[2:3], v[78:79], v[64:65] op_sel:[0,0] op_sel_hi:[1,0]
    v_pk_fma_f32 v[78:79], v[78:79], v[64:65], v[2:3] op_sel:[1,1,0] op_sel_hi:[0,1,1] neg_lo:[1,0,0]
    v_pk_mul_f32 v[4:5], v[84:85], v[68:69] op_sel:[0,0] op_sel_hi:[1,0]
    v_pk_fma_f32 v[76:77], v[84:85], v[68:69], v[4:5] op_sel:[1,1,0] op_sel_hi:[0,1,1] neg_lo:[1,0,0]
    v_cvt_pk_bf16_f32 v10, v78, -v79
    v_cvt_pk_bf16_f32 v11, v76, -v77
    ds_write2st64_b32 v17, v12, v13 offset0:33 offset1:49
    v_pk_mul_f32 v[2:3], v[78:79], v[64:65] op_sel:[0,0] op_sel_hi:[1,0]
    v_pk_fma_f32 v[78:79], v[78:79], v[64:65], v[2:3] op_sel:[1,1,0] op_sel_hi:[0,1,1] neg_lo:[1,0,0]
    v_pk_mul_f32 v[4:5], v[86:87], v[68:69] op_sel:[0,0] op_sel_hi:[1,0]
    v_pk_fma_f32 v[76:77], v[86:87], v[68:69], v[4:5] op_sel:[1,1,0] op_sel_hi:[0,1,1] neg_lo:[1,0,0]
    v_cvt_pk_bf16_f32 v12, v78, -v79
    v_cvt_pk_bf16_f32 v13, v76, -v77
    ds_write2st64_b32 v18, v8, v9 offset0:34 offset1:50
    v_pk_mul_f32 v[4:5], v[86:87], v[72:73] op_sel:[0,0] op_sel_hi:[1,0]
    v_pk_fma_f32 v[76:77], v[86:87], v[72:73], v[4:5] op_sel:[1,1,0] op_sel_hi:[0,1,1] neg_lo:[1,0,0]
    v_cvt_pk_bf16_f32 v8, v82, -v83
    ds_write2st64_b32 v19, v10, v11 offset0:35 offset1:51
    v_pk_mul_f32 v[2:3], v[78:79], v[64:65] op_sel:[0,0] op_sel_hi:[1,0]
    v_pk_fma_f32 v[78:79], v[78:79], v[64:65], v[2:3] op_sel:[1,1,0] op_sel_hi:[0,1,1] neg_lo:[1,0,0]
    v_cvt_pk_bf16_f32 v10, v78, -v79
    ds_write2st64_b32 v20, v12, v13 offset0:36 offset1:52
    v_cvt_pk_bf16_f32 v12, v76, -v77
    ds_write_b32 v24, v8 offset:10240
    v_pk_mul_f32 v[2:3], v[78:79], v[64:65] op_sel:[0,0] op_sel_hi:[1,0]
    v_pk_fma_f32 v[78:79], v[78:79], v[64:65], v[2:3] op_sel:[1,1,0] op_sel_hi:[0,1,1] neg_lo:[1,0,0]
    v_pk_mul_f32 v[4:5], v[76:77], v[72:73] op_sel:[0,0] op_sel_hi:[1,0]
    v_pk_fma_f32 v[76:77], v[76:77], v[72:73], v[4:5] op_sel:[1,1,0] op_sel_hi:[0,1,1] neg_lo:[1,0,0]
    v_cvt_pk_bf16_f32 v8, v78, -v79
    ds_write_b32 v21, v10 offset:9472
    v_cvt_pk_bf16_f32 v10, v76, -v77
    ds_write_b32 v27, v12 offset:11008
    v_pk_mul_f32 v[2:3], v[78:79], v[64:65] op_sel:[0,0] op_sel_hi:[1,0]
    v_pk_fma_f32 v[78:79], v[78:79], v[64:65], v[2:3] op_sel:[1,1,0] op_sel_hi:[0,1,1] neg_lo:[1,0,0]
    v_pk_mul_f32 v[4:5], v[76:77], v[72:73] op_sel:[0,0] op_sel_hi:[1,0]
    v_pk_fma_f32 v[76:77], v[76:77], v[72:73], v[4:5] op_sel:[1,1,0] op_sel_hi:[0,1,1] neg_lo:[1,0,0]
    v_cvt_pk_bf16_f32 v12, v78, -v79
    ds_write_b32 v22, v8 offset:9728
    v_cvt_pk_bf16_f32 v8, v76, -v77
    ds_write_b32 v28, v10 offset:11264
    v_pk_mul_f32 v[4:5], v[76:77], v[72:73] op_sel:[0,0] op_sel_hi:[1,0]
    v_pk_fma_f32 v[76:77], v[76:77], v[72:73], v[4:5] op_sel:[1,1,0] op_sel_hi:[0,1,1] neg_lo:[1,0,0]
    v_cvt_pk_bf16_f32 v10, v84, -v85
    ds_write_b32 v23, v12 offset:9984
    v_cvt_pk_bf16_f32 v12, v76, -v77
    ds_write_b32 v29, v8 offset:11520
    v_pk_mul_f32 v[4:5], v[76:77], v[72:73] op_sel:[0,0] op_sel_hi:[1,0]
    v_pk_fma_f32 v[76:77], v[76:77], v[72:73], v[4:5] op_sel:[1,1,0] op_sel_hi:[0,1,1] neg_lo:[1,0,0]
    v_cvt_pk_bf16_f32 v8, v86, -v87
    ds_write_b32 v25, v10 offset:10496
    v_cvt_pk_bf16_f32 v10, v76, -v77
    ds_write_b32 v30, v12 offset:11776
    ds_write_b32 v26, v8 offset:10752
    ds_write_b32 v31, v10 offset:12032
    s_waitcnt lgkmcnt(0)
    ds_read_b128 v[88:91], v32
    ds_read_b128 v[120:123], v40
    ds_read_b128 v[92:95], v33
    ds_read_b128 v[124:127], v41
    ds_read_b128 v[96:99], v34
    ds_read_b128 v[128:131], v42
    ds_read_b128 v[100:103], v35
    ds_read_b128 v[132:135], v43
    ds_read_b128 v[104:107], v36
    ds_read_b128 v[136:139], v44
    ds_read_b128 v[108:111], v37
    ds_read_b128 v[140:143], v45
    ds_read_b128 v[112:115], v38
    ds_read_b128 v[144:147], v46
    ds_read_b128 v[116:119], v39
    ds_read_b128 v[148:151], v47
    v_lshlrev_b32 v8, 16, v152
    v_mul_f32 v8, 0x3fb8aa3b, v8
    v_exp_f32 v8, v8
    v_lshlrev_b32 v15, 16, v153
    v_mul_f32 v15, v15, v6
    v_mul_f32 v15, 0.15915494, v15
    v_cvt_pk_bf16_f32 v8, v8, v8
    v_lshlrev_b32 v8, 16, v8
    s_waitcnt lgkmcnt(14)
    v_mfma_f32_32x32x16_bf16 v[48:63], v[88:91], v[120:123], v[48:63]
    v_mul_f32 v14, v8, v6
    v_mul_f32 v14, 0xbfb8aa3b, v14
    v_lshlrev_b32 v80, 16, v154
    v_lshlrev_b32 v81, 16, v155
    v_mul_f32 v80, v80, v7
    v_mul_f32 v81, v81, v7
    v_exp_f32 v8, v14
    v_fract_f32 v9, v15
    s_waitcnt lgkmcnt(12)
    v_mfma_f32_32x32x16_bf16 v[48:63], v[92:95], v[124:127], v[48:63]
    v_cos_f32 v64, v9
    v_sin_f32 v65, v9
    v_mul_f32 v64, v8, v64
    v_mul_f32 v65, v8, v65
    v_mul_f32 v8, 0x41000000, v14
    v_mul_f32 v9, 0x41000000, v15
    v_exp_f32 v8, v8
    v_fract_f32 v9, v9
    s_waitcnt lgkmcnt(10)
    v_mfma_f32_32x32x16_bf16 v[48:63], v[96:99], v[128:131], v[48:63]
    v_cos_f32 v70, v9
    v_sin_f32 v71, v9
    v_mul_f32 v70, v8, v70
    v_mul_f32 v71, v8, v71
    v_mul_f32 v8, 0x43800000, v14
    v_mul_f32 v9, 0x43800000, v15
    v_exp_f32 v8, v8
    v_fract_f32 v9, v9
    s_waitcnt lgkmcnt(8)
    v_mfma_f32_32x32x16_bf16 v[48:63], v[100:103], v[132:135], v[48:63]
    v_cos_f32 v72, v9
    v_sin_f32 v73, v9
    v_mul_f32 v72, v8, v72
    v_mul_f32 v73, v8, v73
    v_mul_f32 v8, 0x43000000, v14
    v_mul_f32 v9, 0x43000000, v15
    v_exp_f32 v8, v8
    v_fract_f32 v9, v9
    s_waitcnt lgkmcnt(6)
    v_mfma_f32_32x32x16_bf16 v[48:63], v[104:107], v[136:139], v[48:63]
    v_cos_f32 v74, v9
    v_sin_f32 v75, v9
    v_mul_f32 v74, v8, v74
    v_mul_f32 v75, v8, v75
    v_pk_mul_f32 v[2:3], v[64:65], v[64:65] op_sel:[0,0] op_sel_hi:[1,0]
    v_pk_fma_f32 v[66:67], v[64:65], v[64:65], v[2:3] op_sel:[1,1,0] op_sel_hi:[0,1,1] neg_lo:[1,0,0]
    v_pk_mul_f32 v[2:3], v[66:67], v[66:67] op_sel:[0,0] op_sel_hi:[1,0]
    v_pk_fma_f32 v[68:69], v[66:67], v[66:67], v[2:3] op_sel:[1,1,0] op_sel_hi:[0,1,1] neg_lo:[1,0,0]
    s_waitcnt lgkmcnt(4)
    v_mfma_f32_32x32x16_bf16 v[48:63], v[108:111], v[140:143], v[48:63]
    v_pk_mul_f32 v[2:3], v[80:81], v[72:73] op_sel:[0,0] op_sel_hi:[1,0]
    v_pk_fma_f32 v[82:83], v[80:81], v[72:73], v[2:3] op_sel:[1,1,0] op_sel_hi:[0,1,1] neg_lo:[1,0,0]
    v_pk_mul_f32 v[2:3], v[82:83], v[72:73] op_sel:[0,0] op_sel_hi:[1,0]
    v_pk_fma_f32 v[84:85], v[82:83], v[72:73], v[2:3] op_sel:[1,1,0] op_sel_hi:[0,1,1] neg_lo:[1,0,0]
    v_pk_mul_f32 v[2:3], v[84:85], v[72:73] op_sel:[0,0] op_sel_hi:[1,0]
    v_pk_fma_f32 v[86:87], v[84:85], v[72:73], v[2:3] op_sel:[1,1,0] op_sel_hi:[0,1,1] neg_lo:[1,0,0]
    v_mov_b32 v152, v156
    v_mov_b32 v153, v157
    s_waitcnt lgkmcnt(2)
    v_mfma_f32_32x32x16_bf16 v[48:63], v[112:115], v[144:147], v[48:63]
    v_mov_b32 v154, v158
    v_mov_b32 v155, v159
    v_mov_b32 v156, v160
    v_mov_b32 v157, v161
    v_mov_b32 v158, v162
    v_mov_b32 v159, v163
    s_waitcnt lgkmcnt(0)
    v_mfma_f32_32x32x16_bf16 v[48:63], v[116:119], v[148:151], v[48:63]
    s_sub_u32 s23, s23, 1
    s_cmp_lg_u32 s23, 0
    s_cbranch_scc1 L_GEN
    v_and_b32 v2, 63, v0
    v_and_b32 v8, 31, v2
    v_lshrrev_b32 v9, 5, v2
    v_lshlrev_b32 v10, 2, v8
    v_lshl_add_u32 v10, v9, 9, v10
    v_add_u32 v10, s21, v10
    s_add_u32 s22, s15, 5088
    v_lshlrev_b32 v11, 4, v2
    v_add_u32 v11, s22, v11
    s_mov_b32 s23, 0x0000ffff
    v_lshlrev_b32 v13, 2, v8
    v_add_u32 v13, s21, v13
    v_lshlrev_b32 v14, 2, v2
    v_add_u32 v14, s21, v14
    v_cvt_pk_bf16_f32 v16, v48, v48
    v_cvt_pk_bf16_f32 v17, v49, v49
    v_cvt_pk_bf16_f32 v18, v50, v50
    v_cvt_pk_bf16_f32 v19, v51, v51
    v_cvt_pk_bf16_f32 v20, v52, v52
    v_cvt_pk_bf16_f32 v21, v53, v53
    v_cvt_pk_bf16_f32 v22, v54, v54
    v_cvt_pk_bf16_f32 v23, v55, v55
    v_cvt_pk_bf16_f32 v24, v56, v56
    v_cvt_pk_bf16_f32 v25, v57, v57
    v_cvt_pk_bf16_f32 v26, v58, v58
    v_cvt_pk_bf16_f32 v27, v59, v59
    ds_write_b32 v10, v16 offset:0
    ds_write_b32 v10, v17 offset:128
    ds_write_b32 v10, v18 offset:256
    ds_write_b32 v10, v19 offset:384
    ds_write_b32 v10, v20 offset:1024
    ds_write_b32 v10, v21 offset:1152
    ds_write_b32 v10, v22 offset:1280
    ds_write_b32 v10, v23 offset:1408
    ds_write_b32 v10, v24 offset:2048
    ds_write_b32 v10, v25 offset:2176
    ds_write_b32 v10, v26 offset:2304
    ds_write_b32 v10, v27 offset:2432
    s_waitcnt lgkmcnt(0)
    ds_read_b32 v64, v13 offset:0
    ds_read_b32 v65, v13 offset:128
    ds_read_b32 v66, v13 offset:256
    ds_read_b32 v67, v13 offset:384
    ds_read_b32 v68, v13 offset:512
    ds_read_b32 v69, v13 offset:640
    ds_read_b32 v70, v13 offset:768
    ds_read_b32 v71, v13 offset:896
    ds_read_b32 v72, v13 offset:1024
    ds_read_b32 v73, v13 offset:2048
    ds_read_b32 v74, v13 offset:2176
    ds_read_b32 v75, v13 offset:2304
    ds_read_b32 v76, v13 offset:1028
    ds_read_b32 v77, v14 offset:1152
    ds_read_b32 v78, v14 offset:2432
    s_waitcnt lgkmcnt(4)
    ds_read_b32 v79, v14 offset:1156
    ds_read_b32 v80, v14 offset:1408
    ds_read_b32 v81, v14 offset:1412
    ds_read_b32 v82, v14 offset:1664
    ds_read_b32 v83, v14 offset:1668
    v_cmp_gt_u32 vcc, 32, v2
    v_and_b32 v15, 1, v2
    v_cmp_eq_u32 s[24:25], 1, v15
    s_waitcnt lgkmcnt(0)
    v_bfi_b32 v88, s23, v64, v65
    v_bfi_b32 v89, s23, v66, v67
    v_bfi_b32 v90, s23, v68, v69
    v_bfi_b32 v91, s23, v70, v71
    v_mov_b32 v92, v72
    v_bfi_b32 v93, s23, v73, v74
    v_mov_b32 v94, v74
    v_bfi_b32 v95, s23, v75, v76
    v_cndmask_b32 v88, v92, v88, vcc
    v_cndmask_b32 v89, v93, v89, vcc
    v_cndmask_b32 v90, v94, v90, vcc
    v_cndmask_b32 v91, v95, v91, vcc
    v_mov_b32 v96, v77
    v_bfi_b32 v97, s23, v77, v78
    v_mov_b32 v98, v78
    v_mov_b32 v99, v79
    v_mov_b32 v100, v80
    v_mov_b32 v101, v80
    v_bfi_b32 v102, s23, v80, v81
    v_cndmask_b32 v102, v102, v81, s[24:25]
    v_mov_b32 v103, v81
    v_mov_b32 v104, v82
    v_mov_b32 v105, v82
    v_bfi_b32 v106, s23, v82, v83
    v_cndmask_b32 v106, v106, v83, s[24:25]
    v_mov_b32 v107, v83
    ds_write_b128 v11, v[88:91]
    ds_write_b128 v11, v[96:99] offset:1024
    ds_write_b128 v11, v[100:103] offset:2048
    ds_write_b128 v11, v[104:107] offset:3072
    s_branch L_PRE_B2
L_PRE_B2:
    s_setprio 0
    s_lshl_b32 s22, s16, 1
    s_and_b32 s22, s22, 0xfffffffc
    s_load_dword s8, s[50:51], s22
    s_add_u32 s14, s16, 1
    s_lshl_b32 s22, s14, 1
    s_and_b32 s22, s22, 0xfffffffc
    s_load_dword s9, s[50:51], s22
    s_lshl_b32 s22, s17, 1
    s_and_b32 s22, s22, 0xfffffffc
    s_load_dword s10, s[50:51], s22
    s_lshl_b32 s22, s16, 1
    s_and_b32 s22, s22, 0xfffffffc
    s_load_dword s11, s[52:53], s22
    s_add_u32 s14, s16, 1
    s_lshl_b32 s22, s14, 1
    s_and_b32 s22, s22, 0xfffffffc
    s_load_dword s12, s[52:53], s22
    s_lshl_b32 s22, s17, 1
    s_and_b32 s22, s22, 0xfffffffc
    s_load_dword s13, s[52:53], s22
    s_mov_b32 s60, s64
    s_and_b32 s61, s65, 0xffff
    s_mov_b32 s62, 16777216
    s_mov_b32 s63, 0x00020000
    v_and_b32 v2, 63, v0
    s_lshr_b32 s21, s3, 1
    s_add_u32 s22, s16, s21
    s_cmp_ge_u32 s3, 4
    s_cselect_b32 s22, s17, s22
    s_and_b32 s23, s3, 1
    s_lshl_b32 s14, s22, 1
    s_add_u32 s14, s14, s23
    s_mul_i32 s14, s14, 4224
    s_add_u32 s24, s64, s14
    s_addc_u32 s25, s65, 0
    s_and_b32 s25, s25, 0xffff
    s_mov_b32 s26, 4096
    s_mov_b32 s27, 0x00020000
    s_mul_i32 s34, s3, 16640
    s_mul_i32 s35, s3, 4608
    s_add_u32 s35, s35, 99840
    v_lshlrev_b32 v3, 4, v2
    v_add_u32 v4, 4, v3
    v_and_b32 v8, 15, v2
    v_lshrrev_b32 v9, 4, v2
    v_sub_u32 v10, 3, v8
    v_and_b32 v10, 3, v10
    v_lshlrev_b32 v11, 3, v9
    v_sub_u32 v11, v11, v8
    v_add_u32 v11, 2031, v11
    v_sub_u32 v11, v11, v10
    v_lshlrev_b32 v11, 1, v11
    v_mul_u32_u24 v12, 4160, v10
    v_add_u32 v11, v11, v12
    v_subrev_u32 v11, 4032, v11
    v_lshlrev_b32 v12, 5, v8
    v_lshl_add_u32 v12, v9, 4, v12
    v_add_u32 v13, s34, v11
    v_add_u32 v14, s35, v12
    s_add_u32 s36, s23, 4
    s_mul_i32 s37, s36, 16640
    s_mul_i32 s38, s36, 4608
    s_add_u32 s38, s38, 99840
    s_lshr_b32 s39, s3, 1
    s_sub_u32 s39, 1, s39
    s_lshl_b32 s39, s39, 8
    s_add_u32 s40, s37, s39
    s_add_u32 s41, s38, s39
    v_add_u32 v15, s40, v11
    v_add_u32 v16, s41, v12
    v_lshlrev_b32 v17, 5, v8
    v_lshl_add_u32 v17, v9, 3, v17
    v_add_u32 v19, s35, v17
    v_lshrrev_b32 v5, 1, v2
    v_mul_u32_u24 v5, 4160, v5
    v_and_b32 v6, 1, v2
    v_lshl_add_u32 v5, v6, 4, v5
    v_add_u32 v5, s34, v5
    v_add_u32 v18, s34, v3
    v_mov_b32 v8, 0
    v_mov_b32 v9, 0
    v_mov_b32 v10, 0
    v_mov_b32 v11, 0
    s_and_b32 s14, s3, 5
    s_cmp_eq_u32 s14, 4
    s_cbranch_scc1 L_B3W
    s_waitcnt vmcnt(0)
L_B3W:
    s_waitcnt lgkmcnt(0)
    s_barrier
    s_cmp_ge_u32 s3, 4
    s_cbranch_scc1 L_HELP
    buffer_load_dwordx4 v[64:67], v3, s[24:27], 0 offen offset:0 sc1
    buffer_load_dwordx4 v[68:71], v3, s[24:27], 0 offen offset:16 sc1
    buffer_load_dwordx4 v[72:75], v3, s[24:27], 0 offen offset:1024 sc1
    buffer_load_dwordx4 v[76:79], v3, s[24:27], 0 offen offset:1040 sc1
    buffer_load_dwordx4 v[80:83], v3, s[24:27], 0 offen offset:2048 sc1
    buffer_load_dwordx4 v[84:87], v3, s[24:27], 0 offen offset:2064 sc1
    buffer_load_dwordx4 v[88:91], v3, s[24:27], 0 offen offset:3072 sc1
    buffer_load_dwordx4 v[92:95], v3, s[24:27], 0 offen offset:3088 sc1
    s_mov_b64 exec, 0xff
    ds_write_b128 v5, v[8:11] offset:4096
    s_mov_b64 exec, -1
    s_waitcnt vmcnt(6)
    v_alignbit_b32 v96, v65, v64, 16
    v_alignbit_b32 v97, v66, v65, 16
    v_alignbit_b32 v98, v67, v66, 16
    v_alignbit_b32 v99, v68, v67, 16
    v_alignbit_b32 v100, v66, v65, 16
    v_alignbit_b32 v101, v67, v66, 16
    v_alignbit_b32 v102, v68, v67, 16
    v_alignbit_b32 v103, v69, v68, 16
    ds_write_b128 v18, v[96:99] offset:4160
    ds_write_b128 v18, v[100:103] offset:12480
    s_waitcnt vmcnt(4)
    v_alignbit_b32 v96, v73, v72, 16
    v_alignbit_b32 v97, v74, v73, 16
    v_alignbit_b32 v98, v75, v74, 16
    v_alignbit_b32 v99, v76, v75, 16
    v_alignbit_b32 v100, v74, v73, 16
    v_alignbit_b32 v101, v75, v74, 16
    v_alignbit_b32 v102, v76, v75, 16
    v_alignbit_b32 v103, v77, v76, 16
    ds_write_b128 v18, v[96:99] offset:5184
    ds_write_b128 v18, v[100:103] offset:13504
    s_waitcnt vmcnt(2)
    v_alignbit_b32 v96, v81, v80, 16
    v_alignbit_b32 v97, v82, v81, 16
    v_alignbit_b32 v98, v83, v82, 16
    v_alignbit_b32 v99, v84, v83, 16
    v_alignbit_b32 v100, v82, v81, 16
    v_alignbit_b32 v101, v83, v82, 16
    v_alignbit_b32 v102, v84, v83, 16
    v_alignbit_b32 v103, v85, v84, 16
    ds_write_b128 v18, v[96:99] offset:6208
    ds_write_b128 v18, v[100:103] offset:14528
    s_waitcnt vmcnt(0)
    v_alignbit_b32 v96, v89, v88, 16
    v_alignbit_b32 v97, v90, v89, 16
    v_alignbit_b32 v98, v91, v90, 16
    v_alignbit_b32 v99, v92, v91, 16
    v_alignbit_b32 v100, v90, v89, 16
    v_alignbit_b32 v101, v91, v90, 16
    v_alignbit_b32 v102, v92, v91, 16
    v_alignbit_b32 v103, v93, v92, 16
    ds_write_b128 v18, v[96:99] offset:7232
    ds_write_b128 v18, v[100:103] offset:15552
    s_waitcnt vmcnt(0) lgkmcnt(0)
    s_waitcnt lgkmcnt(0)
    s_and_b32 s22, s16, 1
    s_lshl_b32 s22, s22, 4
    s_lshr_b32 s8, s8, s22
    s_lshl_b32 s8, s8, 16
    s_add_u32 s14, s16, 1
    s_and_b32 s22, s14, 1
    s_lshl_b32 s22, s22, 4
    s_lshr_b32 s9, s9, s22
    s_lshl_b32 s9, s9, 16
    s_and_b32 s22, s17, 1
    s_lshl_b32 s22, s22, 4
    s_lshr_b32 s10, s10, s22
    s_lshl_b32 s10, s10, 16
    s_and_b32 s22, s16, 1
    s_lshl_b32 s22, s22, 4
    s_lshr_b32 s11, s11, s22
    s_lshl_b32 s11, s11, 16
    s_add_u32 s14, s16, 1
    s_and_b32 s22, s14, 1
    s_lshl_b32 s22, s22, 4
    s_lshr_b32 s12, s12, s22
    s_lshl_b32 s12, s12, 16
    s_and_b32 s22, s17, 1
    s_lshl_b32 s22, s22, 4
    s_lshr_b32 s13, s13, s22
    s_lshl_b32 s13, s13, 16
    s_add_u32 s28, s64, 8388608
    s_addc_u32 s29, s65, 0
    s_and_b32 s29, s29, 0xffff
    s_mov_b32 s30, 2703360
    s_mov_b32 s31, 0x00020000
    s_lshl_b32 s36, s3, 12
    s_add_u32 s36, s36, 143872
    v_add_u32 v196, s36, v3
    s_lshl_b32 s36, s3, 10
    s_add_u32 s36, s36, 143872
    v_add_u32 v197, s36, v3
    s_and_b32 s36, s3, 1
    s_xor_b32 s36, s36, s18
    s_lshl_b32 s37, s3, 1
    s_add_u32 s36, s36, s37
    s_lshl_b32 s36, s36, 9
    v_add_u32 v12, s36, v17
    v_sub_u32 v198, 70648, v12
    v_lshlrev_b32 v199, 1, v12
    v_add_u32 v199, 127488, v199
    s_mul_i32 s47, s17, 4224
    v_add_u32 v12, s47, v12
    s_barrier
    ds_read_b64 v[20:21], v13 offset:4032
    ds_read_b64 v[22:23], v13 offset:4040
    ds_read_b128 v[52:55], v14 offset:448
    ds_read_b128 v[56:59], v14 offset:960
    ds_read_b128 v[60:63], v14 offset:1472
    ds_read_b128 v[64:67], v14 offset:1984
    ds_read_b128 v[68:71], v14 offset:2496
    ds_read_b128 v[72:75], v14 offset:3008
    ds_read_b128 v[76:79], v14 offset:3520
    ds_read_b128 v[80:83], v14 offset:4032
    ds_read_b64 v[24:25], v13 offset:3520
    ds_read_b64 v[26:27], v13 offset:3528
    ds_read_b64 v[28:29], v13 offset:3008
    ds_read_b64 v[30:31], v13 offset:3016
    ds_read_b64 v[32:33], v13 offset:2496
    ds_read_b64 v[34:35], v13 offset:2504
    ds_read_b64 v[36:37], v13 offset:1984
    ds_read_b64 v[38:39], v13 offset:1992
    ds_read_b64 v[40:41], v13 offset:1472
    ds_read_b64 v[42:43], v13 offset:1480
    ds_read_b64 v[44:45], v13 offset:960
    ds_read_b64 v[46:47], v13 offset:968
    ds_read_b64 v[48:49], v13 offset:448
    ds_read_b64 v[50:51], v13 offset:456
    v_mov_b32 v6, 163820
    s_waitcnt lgkmcnt(0)
    v_mfma_f32_16x16x32_bf16 v[148:151], v[20:23], v[52:55], 0
    ds_read_b64 v[84:85], v13 offset:3968
    v_mfma_f32_16x16x32_bf16 v[152:155], v[20:23], v[56:59], 0
    ds_read_b64 v[86:87], v13 offset:3976
    v_mfma_f32_16x16x32_bf16 v[156:159], v[20:23], v[60:63], 0
    ds_read_b128 v[116:119], v14 offset:384
    v_mfma_f32_16x16x32_bf16 v[160:163], v[20:23], v[64:67], 0
    ds_read_b128 v[120:123], v14 offset:896
    v_mfma_f32_16x16x32_bf16 v[164:167], v[20:23], v[68:71], 0
    ds_read_b128 v[124:127], v14 offset:1408
    v_mfma_f32_16x16x32_bf16 v[168:171], v[20:23], v[72:75], 0
    ds_read_b128 v[128:131], v14 offset:1920
    v_mfma_f32_16x16x32_bf16 v[172:175], v[20:23], v[76:79], 0
    ds_read_b128 v[132:135], v14 offset:2432
    v_mfma_f32_16x16x32_bf16 v[176:179], v[20:23], v[80:83], 0
    ds_read_b128 v[136:139], v14 offset:2944
    v_mfma_f32_16x16x32_bf16 v[152:155], v[24:27], v[52:55], v[152:155]
    v_mfma_f32_16x16x32_bf16 v[156:159], v[24:27], v[56:59], v[156:159]
    ds_read_b128 v[140:143], v14 offset:3456
    v_mfma_f32_16x16x32_bf16 v[160:163], v[24:27], v[60:63], v[160:163]
    ds_read_b128 v[144:147], v14 offset:3968
    v_mfma_f32_16x16x32_bf16 v[164:167], v[24:27], v[64:67], v[164:167]
    ds_read_b64 v[88:89], v13 offset:3456
    v_mfma_f32_16x16x32_bf16 v[168:171], v[24:27], v[68:71], v[168:171]
    ds_read_b64 v[90:91], v13 offset:3464
    v_mfma_f32_16x16x32_bf16 v[172:175], v[24:27], v[72:75], v[172:175]
    ds_read_b64 v[92:93], v13 offset:2944
    v_mfma_f32_16x16x32_bf16 v[176:179], v[24:27], v[76:79], v[176:179]
    ds_read_b64 v[94:95], v13 offset:2952
    v_mfma_f32_16x16x32_bf16 v[156:159], v[28:31], v[52:55], v[156:159]
    ds_read_b64 v[96:97], v13 offset:2432
    v_mfma_f32_16x16x32_bf16 v[160:163], v[28:31], v[56:59], v[160:163]
    ds_read_b64 v[98:99], v13 offset:2440
    v_mfma_f32_16x16x32_bf16 v[164:167], v[28:31], v[60:63], v[164:167]
    v_mfma_f32_16x16x32_bf16 v[168:171], v[28:31], v[64:67], v[168:171]
    ds_read_b64 v[100:101], v13 offset:1920
    v_mfma_f32_16x16x32_bf16 v[172:175], v[28:31], v[68:71], v[172:175]
    ds_read_b64 v[102:103], v13 offset:1928
    v_mfma_f32_16x16x32_bf16 v[176:179], v[28:31], v[72:75], v[176:179]
    ds_read_b64 v[104:105], v13 offset:1408
    v_mfma_f32_16x16x32_bf16 v[160:163], v[32:35], v[52:55], v[160:163]
    ds_read_b64 v[106:107], v13 offset:1416
    v_mfma_f32_16x16x32_bf16 v[164:167], v[32:35], v[56:59], v[164:167]
    ds_read_b64 v[108:109], v13 offset:896
    v_mfma_f32_16x16x32_bf16 v[168:171], v[32:35], v[60:63], v[168:171]
    ds_read_b64 v[110:111], v13 offset:904
    v_mfma_f32_16x16x32_bf16 v[172:175], v[32:35], v[64:67], v[172:175]
    ds_read_b64 v[112:113], v13 offset:384
    v_mfma_f32_16x16x32_bf16 v[176:179], v[32:35], v[68:71], v[176:179]
    ds_read_b64 v[114:115], v13 offset:392
    v_mfma_f32_16x16x32_bf16 v[164:167], v[36:39], v[52:55], v[164:167]
    v_mfma_f32_16x16x32_bf16 v[168:171], v[36:39], v[56:59], v[168:171]
    v_mfma_f32_16x16x32_bf16 v[172:175], v[36:39], v[60:63], v[172:175]
    v_mfma_f32_16x16x32_bf16 v[176:179], v[36:39], v[64:67], v[176:179]
    v_mfma_f32_16x16x32_bf16 v[168:171], v[40:43], v[52:55], v[168:171]
    v_mfma_f32_16x16x32_bf16 v[172:175], v[40:43], v[56:59], v[172:175]
    v_mfma_f32_16x16x32_bf16 v[176:179], v[40:43], v[60:63], v[176:179]
    v_mfma_f32_16x16x32_bf16 v[172:175], v[44:47], v[52:55], v[172:175]
    v_mfma_f32_16x16x32_bf16 v[176:179], v[44:47], v[56:59], v[176:179]
    v_mfma_f32_16x16x32_bf16 v[176:179], v[48:51], v[52:55], v[176:179]
    s_waitcnt lgkmcnt(0)
    v_mfma_f32_16x16x32_bf16 v[148:151], v[84:87], v[116:119], v[148:151]
    ds_read_b64 v[20:21], v13 offset:3904
    v_mfma_f32_16x16x32_bf16 v[152:155], v[84:87], v[120:123], v[152:155]
    ds_read_b64 v[22:23], v13 offset:3912
    v_mfma_f32_16x16x32_bf16 v[156:159], v[84:87], v[124:127], v[156:159]
    ds_read_b128 v[52:55], v14 offset:320
    v_mfma_f32_16x16x32_bf16 v[160:163], v[84:87], v[128:131], v[160:163]
    ds_read_b128 v[56:59], v14 offset:832
    v_mfma_f32_16x16x32_bf16 v[164:167], v[84:87], v[132:135], v[164:167]
    ds_read_b128 v[60:63], v14 offset:1344
    v_mfma_f32_16x16x32_bf16 v[168:171], v[84:87], v[136:139], v[168:171]
    ds_read_b128 v[64:67], v14 offset:1856
    v_mfma_f32_16x16x32_bf16 v[172:175], v[84:87], v[140:143], v[172:175]
    ds_read_b128 v[68:71], v14 offset:2368
    v_mfma_f32_16x16x32_bf16 v[176:179], v[84:87], v[144:147], v[176:179]
    ds_read_b128 v[72:75], v14 offset:2880
    v_mfma_f32_16x16x32_bf16 v[152:155], v[88:91], v[116:119], v[152:155]
    v_mfma_f32_16x16x32_bf16 v[156:159], v[88:91], v[120:123], v[156:159]
    ds_read_b128 v[76:79], v14 offset:3392
    v_mfma_f32_16x16x32_bf16 v[160:163], v[88:91], v[124:127], v[160:163]
    ds_read_b128 v[80:83], v14 offset:3904
    v_mfma_f32_16x16x32_bf16 v[164:167], v[88:91], v[128:131], v[164:167]
    ds_read_b64 v[24:25], v13 offset:3392
    v_mfma_f32_16x16x32_bf16 v[168:171], v[88:91], v[132:135], v[168:171]
    ds_read_b64 v[26:27], v13 offset:3400
    v_mfma_f32_16x16x32_bf16 v[172:175], v[88:91], v[136:139], v[172:175]
    ds_read_b64 v[28:29], v13 offset:2880
    v_mfma_f32_16x16x32_bf16 v[176:179], v[88:91], v[140:143], v[176:179]
    ds_read_b64 v[30:31], v13 offset:2888
    v_mfma_f32_16x16x32_bf16 v[156:159], v[92:95], v[116:119], v[156:159]
    ds_read_b64 v[32:33], v13 offset:2368
    v_mfma_f32_16x16x32_bf16 v[160:163], v[92:95], v[120:123], v[160:163]
    ds_read_b64 v[34:35], v13 offset:2376
    v_mfma_f32_16x16x32_bf16 v[164:167], v[92:95], v[124:127], v[164:167]
    v_mfma_f32_16x16x32_bf16 v[168:171], v[92:95], v[128:131], v[168:171]
    ds_read_b64 v[36:37], v13 offset:1856
    v_mfma_f32_16x16x32_bf16 v[172:175], v[92:95], v[132:135], v[172:175]
    ds_read_b64 v[38:39], v13 offset:1864
    v_mfma_f32_16x16x32_bf16 v[176:179], v[92:95], v[136:139], v[176:179]
    ds_read_b64 v[40:41], v13 offset:1344
    v_mfma_f32_16x16x32_bf16 v[160:163], v[96:99], v[116:119], v[160:163]
    ds_read_b64 v[42:43], v13 offset:1352
    v_mfma_f32_16x16x32_bf16 v[164:167], v[96:99], v[120:123], v[164:167]
    ds_read_b64 v[44:45], v13 offset:832
    v_mfma_f32_16x16x32_bf16 v[168:171], v[96:99], v[124:127], v[168:171]
    ds_read_b64 v[46:47], v13 offset:840
    v_mfma_f32_16x16x32_bf16 v[172:175], v[96:99], v[128:131], v[172:175]
    ds_read_b64 v[48:49], v13 offset:320
    v_mfma_f32_16x16x32_bf16 v[176:179], v[96:99], v[132:135], v[176:179]
    ds_read_b64 v[50:51], v13 offset:328
    v_mfma_f32_16x16x32_bf16 v[164:167], v[100:103], v[116:119], v[164:167]
    v_mfma_f32_16x16x32_bf16 v[168:171], v[100:103], v[120:123], v[168:171]
    v_mfma_f32_16x16x32_bf16 v[172:175], v[100:103], v[124:127], v[172:175]
    v_mfma_f32_16x16x32_bf16 v[176:179], v[100:103], v[128:131], v[176:179]
    v_mfma_f32_16x16x32_bf16 v[168:171], v[104:107], v[116:119], v[168:171]
    v_mfma_f32_16x16x32_bf16 v[172:175], v[104:107], v[120:123], v[172:175]
    v_mfma_f32_16x16x32_bf16 v[176:179], v[104:107], v[124:127], v[176:179]
    v_mfma_f32_16x16x32_bf16 v[172:175], v[108:111], v[116:119], v[172:175]
    v_mfma_f32_16x16x32_bf16 v[176:179], v[108:111], v[120:123], v[176:179]
    v_mfma_f32_16x16x32_bf16 v[176:179], v[112:115], v[116:119], v[176:179]
    s_waitcnt lgkmcnt(0)
    v_mfma_f32_16x16x32_bf16 v[148:151], v[20:23], v[52:55], v[148:151]
    ds_read_b64 v[84:85], v13 offset:3840
    v_mfma_f32_16x16x32_bf16 v[152:155], v[20:23], v[56:59], v[152:155]
    ds_read_b64 v[86:87], v13 offset:3848
    v_mfma_f32_16x16x32_bf16 v[156:159], v[20:23], v[60:63], v[156:159]
    ds_read_b128 v[116:119], v14 offset:256
    v_mfma_f32_16x16x32_bf16 v[160:163], v[20:23], v[64:67], v[160:163]
    ds_read_b128 v[120:123], v14 offset:768
    v_mfma_f32_16x16x32_bf16 v[164:167], v[20:23], v[68:71], v[164:167]
    ds_read_b128 v[124:127], v14 offset:1280
    v_mfma_f32_16x16x32_bf16 v[168:171], v[20:23], v[72:75], v[168:171]
    ds_read_b128 v[128:131], v14 offset:1792
    v_mfma_f32_16x16x32_bf16 v[172:175], v[20:23], v[76:79], v[172:175]
    ds_read_b128 v[132:135], v14 offset:2304
    v_mfma_f32_16x16x32_bf16 v[176:179], v[20:23], v[80:83], v[176:179]
    ds_read_b128 v[136:139], v14 offset:2816
    v_mfma_f32_16x16x32_bf16 v[152:155], v[24:27], v[52:55], v[152:155]
    v_mfma_f32_16x16x32_bf16 v[156:159], v[24:27], v[56:59], v[156:159]
    ds_read_b128 v[140:143], v14 offset:3328
    v_mfma_f32_16x16x32_bf16 v[160:163], v[24:27], v[60:63], v[160:163]
    ds_read_b128 v[144:147], v14 offset:3840
    v_mfma_f32_16x16x32_bf16 v[164:167], v[24:27], v[64:67], v[164:167]
    ds_read_b64 v[88:89], v13 offset:3328
    v_mfma_f32_16x16x32_bf16 v[168:171], v[24:27], v[68:71], v[168:171]
    ds_read_b64 v[90:91], v13 offset:3336
    v_mfma_f32_16x16x32_bf16 v[172:175], v[24:27], v[72:75], v[172:175]
    ds_read_b64 v[92:93], v13 offset:2816
    v_mfma_f32_16x16x32_bf16 v[176:179], v[24:27], v[76:79], v[176:179]
    ds_read_b64 v[94:95], v13 offset:2824
    v_mfma_f32_16x16x32_bf16 v[156:159], v[28:31], v[52:55], v[156:159]
    ds_read_b64 v[96:97], v13 offset:2304
    v_mfma_f32_16x16x32_bf16 v[160:163], v[28:31], v[56:59], v[160:163]
    ds_read_b64 v[98:99], v13 offset:2312
    v_mfma_f32_16x16x32_bf16 v[164:167], v[28:31], v[60:63], v[164:167]
    v_mfma_f32_16x16x32_bf16 v[168:171], v[28:31], v[64:67], v[168:171]
    ds_read_b64 v[100:101], v13 offset:1792
    v_mfma_f32_16x16x32_bf16 v[172:175], v[28:31], v[68:71], v[172:175]
    ds_read_b64 v[102:103], v13 offset:1800
    v_mfma_f32_16x16x32_bf16 v[176:179], v[28:31], v[72:75], v[176:179]
    ds_read_b64 v[104:105], v13 offset:1280
    v_mfma_f32_16x16x32_bf16 v[160:163], v[32:35], v[52:55], v[160:163]
    ds_read_b64 v[106:107], v13 offset:1288
    v_mfma_f32_16x16x32_bf16 v[164:167], v[32:35], v[56:59], v[164:167]
    ds_read_b64 v[108:109], v13 offset:768
    v_mfma_f32_16x16x32_bf16 v[168:171], v[32:35], v[60:63], v[168:171]
    ds_read_b64 v[110:111], v13 offset:776
    v_mfma_f32_16x16x32_bf16 v[172:175], v[32:35], v[64:67], v[172:175]
    ds_read_b64 v[112:113], v13 offset:256
    v_mfma_f32_16x16x32_bf16 v[176:179], v[32:35], v[68:71], v[176:179]
    ds_read_b64 v[114:115], v13 offset:264
    v_mfma_f32_16x16x32_bf16 v[164:167], v[36:39], v[52:55], v[164:167]
    v_mfma_f32_16x16x32_bf16 v[168:171], v[36:39], v[56:59], v[168:171]
    v_mfma_f32_16x16x32_bf16 v[172:175], v[36:39], v[60:63], v[172:175]
    v_mfma_f32_16x16x32_bf16 v[176:179], v[36:39], v[64:67], v[176:179]
    v_mfma_f32_16x16x32_bf16 v[168:171], v[40:43], v[52:55], v[168:171]
    v_mfma_f32_16x16x32_bf16 v[172:175], v[40:43], v[56:59], v[172:175]
    v_mfma_f32_16x16x32_bf16 v[176:179], v[40:43], v[60:63], v[176:179]
    v_mfma_f32_16x16x32_bf16 v[172:175], v[44:47], v[52:55], v[172:175]
    v_mfma_f32_16x16x32_bf16 v[176:179], v[44:47], v[56:59], v[176:179]
    v_mfma_f32_16x16x32_bf16 v[176:179], v[48:51], v[52:55], v[176:179]
    s_waitcnt lgkmcnt(0)
    v_mfma_f32_16x16x32_bf16 v[148:151], v[84:87], v[116:119], v[148:151]
    ds_read_b64 v[20:21], v13 offset:3776
    v_mfma_f32_16x16x32_bf16 v[152:155], v[84:87], v[120:123], v[152:155]
    ds_read_b64 v[22:23], v13 offset:3784
    v_mfma_f32_16x16x32_bf16 v[156:159], v[84:87], v[124:127], v[156:159]
    ds_read_b128 v[52:55], v14 offset:192
    v_mfma_f32_16x16x32_bf16 v[160:163], v[84:87], v[128:131], v[160:163]
    ds_read_b128 v[56:59], v14 offset:704
    v_mfma_f32_16x16x32_bf16 v[164:167], v[84:87], v[132:135], v[164:167]
    ds_read_b128 v[60:63], v14 offset:1216
    v_mfma_f32_16x16x32_bf16 v[168:171], v[84:87], v[136:139], v[168:171]
    ds_read_b128 v[64:67], v14 offset:1728
    v_mfma_f32_16x16x32_bf16 v[172:175], v[84:87], v[140:143], v[172:175]
    ds_read_b128 v[68:71], v14 offset:2240
    v_mfma_f32_16x16x32_bf16 v[176:179], v[84:87], v[144:147], v[176:179]
    ds_read_b128 v[72:75], v14 offset:2752
    v_mfma_f32_16x16x32_bf16 v[152:155], v[88:91], v[116:119], v[152:155]
    v_mfma_f32_16x16x32_bf16 v[156:159], v[88:91], v[120:123], v[156:159]
    ds_read_b128 v[76:79], v14 offset:3264
    v_mfma_f32_16x16x32_bf16 v[160:163], v[88:91], v[124:127], v[160:163]
    ds_read_b128 v[80:83], v14 offset:3776
    v_mfma_f32_16x16x32_bf16 v[164:167], v[88:91], v[128:131], v[164:167]
    ds_read_b64 v[24:25], v13 offset:3264
    v_mfma_f32_16x16x32_bf16 v[168:171], v[88:91], v[132:135], v[168:171]
    ds_read_b64 v[26:27], v13 offset:3272
    v_mfma_f32_16x16x32_bf16 v[172:175], v[88:91], v[136:139], v[172:175]
    ds_read_b64 v[28:29], v13 offset:2752
    v_mfma_f32_16x16x32_bf16 v[176:179], v[88:91], v[140:143], v[176:179]
    ds_read_b64 v[30:31], v13 offset:2760
    v_mfma_f32_16x16x32_bf16 v[156:159], v[92:95], v[116:119], v[156:159]
    ds_read_b64 v[32:33], v13 offset:2240
    v_mfma_f32_16x16x32_bf16 v[160:163], v[92:95], v[120:123], v[160:163]
    ds_read_b64 v[34:35], v13 offset:2248
    v_mfma_f32_16x16x32_bf16 v[164:167], v[92:95], v[124:127], v[164:167]
    v_mfma_f32_16x16x32_bf16 v[168:171], v[92:95], v[128:131], v[168:171]
    ds_read_b64 v[36:37], v13 offset:1728
    v_mfma_f32_16x16x32_bf16 v[172:175], v[92:95], v[132:135], v[172:175]
    ds_read_b64 v[38:39], v13 offset:1736
    v_mfma_f32_16x16x32_bf16 v[176:179], v[92:95], v[136:139], v[176:179]
    ds_read_b64 v[40:41], v13 offset:1216
    v_mfma_f32_16x16x32_bf16 v[160:163], v[96:99], v[116:119], v[160:163]
    ds_read_b64 v[42:43], v13 offset:1224
    v_mfma_f32_16x16x32_bf16 v[164:167], v[96:99], v[120:123], v[164:167]
    ds_read_b64 v[44:45], v13 offset:704
    v_mfma_f32_16x16x32_bf16 v[168:171], v[96:99], v[124:127], v[168:171]
    ds_read_b64 v[46:47], v13 offset:712
    v_mfma_f32_16x16x32_bf16 v[172:175], v[96:99], v[128:131], v[172:175]
    ds_read_b64 v[48:49], v13 offset:192
    v_mfma_f32_16x16x32_bf16 v[176:179], v[96:99], v[132:135], v[176:179]
    ds_read_b64 v[50:51], v13 offset:200
    v_mfma_f32_16x16x32_bf16 v[164:167], v[100:103], v[116:119], v[164:167]
    v_mfma_f32_16x16x32_bf16 v[168:171], v[100:103], v[120:123], v[168:171]
    v_mfma_f32_16x16x32_bf16 v[172:175], v[100:103], v[124:127], v[172:175]
    v_mfma_f32_16x16x32_bf16 v[176:179], v[100:103], v[128:131], v[176:179]
    v_mfma_f32_16x16x32_bf16 v[168:171], v[104:107], v[116:119], v[168:171]
    v_mfma_f32_16x16x32_bf16 v[172:175], v[104:107], v[120:123], v[172:175]
    v_mfma_f32_16x16x32_bf16 v[176:179], v[104:107], v[124:127], v[176:179]
    v_mfma_f32_16x16x32_bf16 v[172:175], v[108:111], v[116:119], v[172:175]
    v_mfma_f32_16x16x32_bf16 v[176:179], v[108:111], v[120:123], v[176:179]
    v_mfma_f32_16x16x32_bf16 v[176:179], v[112:115], v[116:119], v[176:179]
    s_waitcnt lgkmcnt(0)
    v_mfma_f32_16x16x32_bf16 v[148:151], v[20:23], v[52:55], v[148:151]
    ds_read_b64 v[84:85], v13 offset:3712
    v_mfma_f32_16x16x32_bf16 v[152:155], v[20:23], v[56:59], v[152:155]
    ds_read_b64 v[86:87], v13 offset:3720
    v_mfma_f32_16x16x32_bf16 v[156:159], v[20:23], v[60:63], v[156:159]
    ds_read_b128 v[116:119], v14 offset:128
    v_mfma_f32_16x16x32_bf16 v[160:163], v[20:23], v[64:67], v[160:163]
    ds_read_b128 v[120:123], v14 offset:640
    v_mfma_f32_16x16x32_bf16 v[164:167], v[20:23], v[68:71], v[164:167]
    ds_read_b128 v[124:127], v14 offset:1152
    v_mfma_f32_16x16x32_bf16 v[168:171], v[20:23], v[72:75], v[168:171]
    ds_read_b128 v[128:131], v14 offset:1664
    v_mfma_f32_16x16x32_bf16 v[172:175], v[20:23], v[76:79], v[172:175]
    ds_read_b128 v[132:135], v14 offset:2176
    v_mfma_f32_16x16x32_bf16 v[176:179], v[20:23], v[80:83], v[176:179]
    ds_read_b128 v[136:139], v14 offset:2688
    v_mfma_f32_16x16x32_bf16 v[152:155], v[24:27], v[52:55], v[152:155]
    v_mfma_f32_16x16x32_bf16 v[156:159], v[24:27], v[56:59], v[156:159]
    ds_read_b128 v[140:143], v14 offset:3200
    v_mfma_f32_16x16x32_bf16 v[160:163], v[24:27], v[60:63], v[160:163]
    ds_read_b128 v[144:147], v14 offset:3712
    v_mfma_f32_16x16x32_bf16 v[164:167], v[24:27], v[64:67], v[164:167]
    ds_read_b64 v[88:89], v13 offset:3200
    v_mfma_f32_16x16x32_bf16 v[168:171], v[24:27], v[68:71], v[168:171]
    ds_read_b64 v[90:91], v13 offset:3208
    v_mfma_f32_16x16x32_bf16 v[172:175], v[24:27], v[72:75], v[172:175]
    ds_read_b64 v[92:93], v13 offset:2688
    v_mfma_f32_16x16x32_bf16 v[176:179], v[24:27], v[76:79], v[176:179]
    ds_read_b64 v[94:95], v13 offset:2696
    v_mfma_f32_16x16x32_bf16 v[156:159], v[28:31], v[52:55], v[156:159]
    ds_read_b64 v[96:97], v13 offset:2176
    v_mfma_f32_16x16x32_bf16 v[160:163], v[28:31], v[56:59], v[160:163]
    ds_read_b64 v[98:99], v13 offset:2184
    v_mfma_f32_16x16x32_bf16 v[164:167], v[28:31], v[60:63], v[164:167]
    v_mfma_f32_16x16x32_bf16 v[168:171], v[28:31], v[64:67], v[168:171]
    ds_read_b64 v[100:101], v13 offset:1664
    v_mfma_f32_16x16x32_bf16 v[172:175], v[28:31], v[68:71], v[172:175]
    ds_read_b64 v[102:103], v13 offset:1672
    v_mfma_f32_16x16x32_bf16 v[176:179], v[28:31], v[72:75], v[176:179]
    ds_read_b64 v[104:105], v13 offset:1152
    v_mfma_f32_16x16x32_bf16 v[160:163], v[32:35], v[52:55], v[160:163]
    ds_read_b64 v[106:107], v13 offset:1160
    v_mfma_f32_16x16x32_bf16 v[164:167], v[32:35], v[56:59], v[164:167]
    ds_read_b64 v[108:109], v13 offset:640
    v_mfma_f32_16x16x32_bf16 v[168:171], v[32:35], v[60:63], v[168:171]
    ds_read_b64 v[110:111], v13 offset:648
    v_mfma_f32_16x16x32_bf16 v[172:175], v[32:35], v[64:67], v[172:175]
    ds_read_b64 v[112:113], v13 offset:128
    v_mfma_f32_16x16x32_bf16 v[176:179], v[32:35], v[68:71], v[176:179]
    ds_read_b64 v[114:115], v13 offset:136
    v_mfma_f32_16x16x32_bf16 v[164:167], v[36:39], v[52:55], v[164:167]
    v_mfma_f32_16x16x32_bf16 v[168:171], v[36:39], v[56:59], v[168:171]
    v_mfma_f32_16x16x32_bf16 v[172:175], v[36:39], v[60:63], v[172:175]
    v_mfma_f32_16x16x32_bf16 v[176:179], v[36:39], v[64:67], v[176:179]
    v_mfma_f32_16x16x32_bf16 v[168:171], v[40:43], v[52:55], v[168:171]
    v_mfma_f32_16x16x32_bf16 v[172:175], v[40:43], v[56:59], v[172:175]
    v_mfma_f32_16x16x32_bf16 v[176:179], v[40:43], v[60:63], v[176:179]
    v_mfma_f32_16x16x32_bf16 v[172:175], v[44:47], v[52:55], v[172:175]
    v_mfma_f32_16x16x32_bf16 v[176:179], v[44:47], v[56:59], v[176:179]
    v_mfma_f32_16x16x32_bf16 v[176:179], v[48:51], v[52:55], v[176:179]
    s_waitcnt lgkmcnt(0)
    v_mfma_f32_16x16x32_bf16 v[148:151], v[84:87], v[116:119], v[148:151]
    ds_read_b64 v[20:21], v13 offset:3648
    v_mfma_f32_16x16x32_bf16 v[152:155], v[84:87], v[120:123], v[152:155]
    ds_read_b64 v[22:23], v13 offset:3656
    v_mfma_f32_16x16x32_bf16 v[156:159], v[84:87], v[124:127], v[156:159]
    ds_read_b128 v[52:55], v14 offset:64
    v_mfma_f32_16x16x32_bf16 v[160:163], v[84:87], v[128:131], v[160:163]
    ds_read_b128 v[56:59], v14 offset:576
    v_mfma_f32_16x16x32_bf16 v[164:167], v[84:87], v[132:135], v[164:167]
    ds_read_b128 v[60:63], v14 offset:1088
    v_mfma_f32_16x16x32_bf16 v[168:171], v[84:87], v[136:139], v[168:171]
    ds_read_b128 v[64:67], v14 offset:1600
    v_mfma_f32_16x16x32_bf16 v[172:175], v[84:87], v[140:143], v[172:175]
    ds_read_b128 v[68:71], v14 offset:2112
    v_mfma_f32_16x16x32_bf16 v[176:179], v[84:87], v[144:147], v[176:179]
    ds_read_b128 v[72:75], v14 offset:2624
    v_mfma_f32_16x16x32_bf16 v[152:155], v[88:91], v[116:119], v[152:155]
    v_mfma_f32_16x16x32_bf16 v[156:159], v[88:91], v[120:123], v[156:159]
    ds_read_b128 v[76:79], v14 offset:3136
    v_mfma_f32_16x16x32_bf16 v[160:163], v[88:91], v[124:127], v[160:163]
    ds_read_b128 v[80:83], v14 offset:3648
    v_mfma_f32_16x16x32_bf16 v[164:167], v[88:91], v[128:131], v[164:167]
    ds_read_b64 v[24:25], v13 offset:3136
    v_mfma_f32_16x16x32_bf16 v[168:171], v[88:91], v[132:135], v[168:171]
    ds_read_b64 v[26:27], v13 offset:3144
    v_mfma_f32_16x16x32_bf16 v[172:175], v[88:91], v[136:139], v[172:175]
    ds_read_b64 v[28:29], v13 offset:2624
    v_mfma_f32_16x16x32_bf16 v[176:179], v[88:91], v[140:143], v[176:179]
    ds_read_b64 v[30:31], v13 offset:2632
    v_mfma_f32_16x16x32_bf16 v[156:159], v[92:95], v[116:119], v[156:159]
    ds_read_b64 v[32:33], v13 offset:2112
    v_mfma_f32_16x16x32_bf16 v[160:163], v[92:95], v[120:123], v[160:163]
    ds_read_b64 v[34:35], v13 offset:2120
    v_mfma_f32_16x16x32_bf16 v[164:167], v[92:95], v[124:127], v[164:167]
    v_mfma_f32_16x16x32_bf16 v[168:171], v[92:95], v[128:131], v[168:171]
    ds_read_b64 v[36:37], v13 offset:1600
    v_mfma_f32_16x16x32_bf16 v[172:175], v[92:95], v[132:135], v[172:175]
    ds_read_b64 v[38:39], v13 offset:1608
    v_mfma_f32_16x16x32_bf16 v[176:179], v[92:95], v[136:139], v[176:179]
    ds_read_b64 v[40:41], v13 offset:1088
    v_mfma_f32_16x16x32_bf16 v[160:163], v[96:99], v[116:119], v[160:163]
    ds_read_b64 v[42:43], v13 offset:1096
    v_mfma_f32_16x16x32_bf16 v[164:167], v[96:99], v[120:123], v[164:167]
    ds_read_b64 v[44:45], v13 offset:576
    v_mfma_f32_16x16x32_bf16 v[168:171], v[96:99], v[124:127], v[168:171]
    ds_read_b64 v[46:47], v13 offset:584
    v_mfma_f32_16x16x32_bf16 v[172:175], v[96:99], v[128:131], v[172:175]
    ds_read_b64 v[48:49], v13 offset:64
    v_mfma_f32_16x16x32_bf16 v[176:179], v[96:99], v[132:135], v[176:179]
    ds_read_b64 v[50:51], v13 offset:72
    v_mfma_f32_16x16x32_bf16 v[164:167], v[100:103], v[116:119], v[164:167]
    v_mfma_f32_16x16x32_bf16 v[168:171], v[100:103], v[120:123], v[168:171]
    v_mfma_f32_16x16x32_bf16 v[172:175], v[100:103], v[124:127], v[172:175]
    v_mfma_f32_16x16x32_bf16 v[176:179], v[100:103], v[128:131], v[176:179]
    v_mfma_f32_16x16x32_bf16 v[168:171], v[104:107], v[116:119], v[168:171]
    v_mfma_f32_16x16x32_bf16 v[172:175], v[104:107], v[120:123], v[172:175]
    v_mfma_f32_16x16x32_bf16 v[176:179], v[104:107], v[124:127], v[176:179]
    v_mfma_f32_16x16x32_bf16 v[172:175], v[108:111], v[116:119], v[172:175]
    v_mfma_f32_16x16x32_bf16 v[176:179], v[108:111], v[120:123], v[176:179]
    v_mfma_f32_16x16x32_bf16 v[176:179], v[112:115], v[116:119], v[176:179]
L_C1:
    ds_read_b32 v7, v6
    s_waitcnt lgkmcnt(0)
    v_cmp_gt_u32 vcc, 2, v7
    s_nop 4
    s_cbranch_vccnz L_C1
    s_waitcnt lgkmcnt(0)
    v_mfma_f32_16x16x32_bf16 v[148:151], v[20:23], v[52:55], v[148:151]
    ds_read_b64 v[84:85], v13 offset:3584
    v_mfma_f32_16x16x32_bf16 v[152:155], v[20:23], v[56:59], v[152:155]
    ds_read_b64 v[86:87], v13 offset:3592
    v_mfma_f32_16x16x32_bf16 v[156:159], v[20:23], v[60:63], v[156:159]
    ds_read_b128 v[116:119], v14 offset:0
    v_mfma_f32_16x16x32_bf16 v[160:163], v[20:23], v[64:67], v[160:163]
    ds_read_b128 v[120:123], v14 offset:512
    v_mfma_f32_16x16x32_bf16 v[164:167], v[20:23], v[68:71], v[164:167]
    ds_read_b128 v[124:127], v14 offset:1024
    v_mfma_f32_16x16x32_bf16 v[168:171], v[20:23], v[72:75], v[168:171]
    ds_read_b128 v[128:131], v14 offset:1536
    v_mfma_f32_16x16x32_bf16 v[172:175], v[20:23], v[76:79], v[172:175]
    ds_read_b128 v[132:135], v14 offset:2048
    v_mfma_f32_16x16x32_bf16 v[176:179], v[20:23], v[80:83], v[176:179]
    ds_read_b128 v[136:139], v14 offset:2560
    v_mfma_f32_16x16x32_bf16 v[152:155], v[24:27], v[52:55], v[152:155]
    v_mfma_f32_16x16x32_bf16 v[156:159], v[24:27], v[56:59], v[156:159]
    ds_read_b128 v[140:143], v14 offset:3072
    v_mfma_f32_16x16x32_bf16 v[160:163], v[24:27], v[60:63], v[160:163]
    ds_read_b128 v[144:147], v14 offset:3584
    v_mfma_f32_16x16x32_bf16 v[164:167], v[24:27], v[64:67], v[164:167]
    ds_read_b64 v[88:89], v13 offset:3072
    v_mfma_f32_16x16x32_bf16 v[168:171], v[24:27], v[68:71], v[168:171]
    ds_read_b64 v[90:91], v13 offset:3080
    v_mfma_f32_16x16x32_bf16 v[172:175], v[24:27], v[72:75], v[172:175]
    ds_read_b64 v[92:93], v13 offset:2560
    v_mfma_f32_16x16x32_bf16 v[176:179], v[24:27], v[76:79], v[176:179]
    ds_read_b64 v[94:95], v13 offset:2568
    v_mfma_f32_16x16x32_bf16 v[156:159], v[28:31], v[52:55], v[156:159]
    ds_read_b64 v[96:97], v13 offset:2048
    v_mfma_f32_16x16x32_bf16 v[160:163], v[28:31], v[56:59], v[160:163]
    ds_read_b64 v[98:99], v13 offset:2056
    v_mfma_f32_16x16x32_bf16 v[164:167], v[28:31], v[60:63], v[164:167]
    v_mfma_f32_16x16x32_bf16 v[168:171], v[28:31], v[64:67], v[168:171]
    ds_read_b64 v[100:101], v13 offset:1536
    v_mfma_f32_16x16x32_bf16 v[172:175], v[28:31], v[68:71], v[172:175]
    ds_read_b64 v[102:103], v13 offset:1544
    v_mfma_f32_16x16x32_bf16 v[176:179], v[28:31], v[72:75], v[176:179]
    ds_read_b64 v[104:105], v13 offset:1024
    v_mfma_f32_16x16x32_bf16 v[160:163], v[32:35], v[52:55], v[160:163]
    ds_read_b64 v[106:107], v13 offset:1032
    v_mfma_f32_16x16x32_bf16 v[164:167], v[32:35], v[56:59], v[164:167]
    ds_read_b64 v[108:109], v13 offset:512
    v_mfma_f32_16x16x32_bf16 v[168:171], v[32:35], v[60:63], v[168:171]
    ds_read_b64 v[110:111], v13 offset:520
    v_mfma_f32_16x16x32_bf16 v[172:175], v[32:35], v[64:67], v[172:175]
    ds_read_b64 v[112:113], v13 offset:0
    v_mfma_f32_16x16x32_bf16 v[176:179], v[32:35], v[68:71], v[176:179]
    ds_read_b64 v[114:115], v13 offset:8
    v_mfma_f32_16x16x32_bf16 v[164:167], v[36:39], v[52:55], v[164:167]
    v_mfma_f32_16x16x32_bf16 v[168:171], v[36:39], v[56:59], v[168:171]
    v_mfma_f32_16x16x32_bf16 v[172:175], v[36:39], v[60:63], v[172:175]
    v_mfma_f32_16x16x32_bf16 v[176:179], v[36:39], v[64:67], v[176:179]
    v_mfma_f32_16x16x32_bf16 v[168:171], v[40:43], v[52:55], v[168:171]
    v_mfma_f32_16x16x32_bf16 v[172:175], v[40:43], v[56:59], v[172:175]
    v_mfma_f32_16x16x32_bf16 v[176:179], v[40:43], v[60:63], v[176:179]
    v_mfma_f32_16x16x32_bf16 v[172:175], v[44:47], v[52:55], v[172:175]
    v_mfma_f32_16x16x32_bf16 v[176:179], v[44:47], v[56:59], v[176:179]
    v_mfma_f32_16x16x32_bf16 v[176:179], v[48:51], v[52:55], v[176:179]
    s_cmp_eq_u32 s18, 0
    s_cbranch_scc0 L_C2_E1
    s_waitcnt lgkmcnt(0)
    v_mfma_f32_16x16x32_bf16 v[148:151], v[84:87], v[116:119], v[148:151]
    v_mfma_f32_16x16x32_bf16 v[152:155], v[84:87], v[120:123], v[152:155]
    ds_read_b64 v[20:21], v15 offset:3776
    v_mfma_f32_16x16x32_bf16 v[156:159], v[84:87], v[124:127], v[156:159]
    ds_read_b64 v[22:23], v15 offset:3784
    v_mfma_f32_16x16x32_bf16 v[160:163], v[84:87], v[128:131], v[160:163]
    ds_read_b128 v[52:55], v16 offset:192
    v_mfma_f32_16x16x32_bf16 v[164:167], v[84:87], v[132:135], v[164:167]
    ds_read_b128 v[64:67], v16 offset:1728
    v_mfma_f32_16x16x32_bf16 v[168:171], v[84:87], v[136:139], v[168:171]
    ds_read_b128 v[68:71], v16 offset:2240
    v_cvt_pk_bf16_f32 v4, v148, v149
    v_cvt_pk_bf16_f32 v5, v150, v151
    v_mfma_f32_16x16x32_bf16 v[172:175], v[84:87], v[140:143], v[172:175]
    ds_read_b128 v[80:83], v16 offset:3776
    v_mfma_f32_16x16x32_bf16 v[176:179], v[84:87], v[144:147], v[176:179]
    ds_read_b64 v[24:25], v15 offset:3264
    ds_write_b64 v19, v[4:5] offset:0
    v_mfma_f32_16x16x32_bf16 v[152:155], v[88:91], v[116:119], v[152:155]
    ds_read_b64 v[26:27], v15 offset:3272
    v_mfma_f32_16x16x32_bf16 v[156:159], v[88:91], v[120:123], v[156:159]
    ds_read_b128 v[60:63], v16 offset:1216
    v_mfma_f32_16x16x32_bf16 v[160:163], v[88:91], v[124:127], v[160:163]
    ds_read_b128 v[76:79], v16 offset:3264
    v_mfma_f32_16x16x32_bf16 v[164:167], v[88:91], v[128:131], v[164:167]
    ds_read_b64 v[28:29], v15 offset:2752
    v_mfma_f32_16x16x32_bf16 v[168:171], v[88:91], v[132:135], v[168:171]
    ds_read_b64 v[30:31], v15 offset:2760
    v_mfma_f32_16x16x32_bf16 v[172:175], v[88:91], v[136:139], v[172:175]
    ds_read_b128 v[56:59], v16 offset:704
    v_cvt_pk_bf16_f32 v6, v152, v153
    v_cvt_pk_bf16_f32 v7, v154, v155
    v_mfma_f32_16x16x32_bf16 v[176:179], v[88:91], v[140:143], v[176:179]
    ds_read_b128 v[72:75], v16 offset:2752
    v_mfma_f32_16x16x32_bf16 v[156:159], v[92:95], v[116:119], v[156:159]
    ds_read_b64 v[32:33], v15 offset:2240
    ds_write_b64 v19, v[6:7] offset:512
    v_mfma_f32_16x16x32_bf16 v[160:163], v[92:95], v[120:123], v[160:163]
    ds_read_b64 v[34:35], v15 offset:2248
    v_mfma_f32_16x16x32_bf16 v[164:167], v[92:95], v[124:127], v[164:167]
    ds_read_b64 v[36:37], v15 offset:1728
    v_mfma_f32_16x16x32_bf16 v[168:171], v[92:95], v[128:131], v[168:171]
    ds_read_b64 v[38:39], v15 offset:1736
    v_mfma_f32_16x16x32_bf16 v[172:175], v[92:95], v[132:135], v[172:175]
    ds_read_b64 v[40:41], v15 offset:1216
    v_mfma_f32_16x16x32_bf16 v[176:179], v[92:95], v[136:139], v[176:179]
    ds_read_b64 v[42:43], v15 offset:1224
    v_cvt_pk_bf16_f32 v4, v156, v157
    v_cvt_pk_bf16_f32 v5, v158, v159
    v_mfma_f32_16x16x32_bf16 v[160:163], v[96:99], v[116:119], v[160:163]
    ds_read_b64 v[44:45], v15 offset:704
    v_mfma_f32_16x16x32_bf16 v[164:167], v[96:99], v[120:123], v[164:167]
    ds_read_b64 v[46:47], v15 offset:712
    ds_write_b64 v19, v[4:5] offset:1024
    v_mfma_f32_16x16x32_bf16 v[168:171], v[96:99], v[124:127], v[168:171]
    ds_read_b64 v[48:49], v15 offset:192
    v_mfma_f32_16x16x32_bf16 v[172:175], v[96:99], v[128:131], v[172:175]
    ds_read_b64 v[50:51], v15 offset:200
    v_mfma_f32_16x16x32_bf16 v[176:179], v[96:99], v[132:135], v[176:179]
    v_mfma_f32_16x16x32_bf16 v[164:167], v[100:103], v[116:119], v[164:167]
    v_cvt_pk_bf16_f32 v6, v160, v161
    v_cvt_pk_bf16_f32 v7, v162, v163
    v_mfma_f32_16x16x32_bf16 v[168:171], v[100:103], v[120:123], v[168:171]
    v_mfma_f32_16x16x32_bf16 v[172:175], v[100:103], v[124:127], v[172:175]
    ds_write_b64 v19, v[6:7] offset:1536
    v_mfma_f32_16x16x32_bf16 v[176:179], v[100:103], v[128:131], v[176:179]
    v_mfma_f32_16x16x32_bf16 v[168:171], v[104:107], v[116:119], v[168:171]
    v_mfma_f32_16x16x32_bf16 v[172:175], v[104:107], v[120:123], v[172:175]
    v_cvt_pk_bf16_f32 v4, v164, v165
    v_cvt_pk_bf16_f32 v5, v166, v167
    v_mfma_f32_16x16x32_bf16 v[176:179], v[104:107], v[124:127], v[176:179]
    v_mfma_f32_16x16x32_bf16 v[172:175], v[108:111], v[116:119], v[172:175]
    ds_write_b64 v19, v[4:5] offset:2048
    v_mfma_f32_16x16x32_bf16 v[176:179], v[108:111], v[120:123], v[176:179]
    v_mfma_f32_16x16x32_bf16 v[176:179], v[112:115], v[116:119], v[176:179]
    s_waitcnt lgkmcnt(0)
    v_mfma_f32_16x16x32_bf16 v[180:183], v[20:23], v[52:55], 0
    ds_read_b64 v[84:85], v15 offset:3712
    ds_read_b64 v[86:87], v15 offset:3720
    v_mfma_f32_16x16x32_bf16 v[184:187], v[20:23], v[64:67], 0
    ds_read_b128 v[116:119], v16 offset:128
    ds_read_b128 v[128:131], v16 offset:1664
    v_mfma_f32_16x16x32_bf16 v[188:191], v[20:23], v[68:71], 0
    ds_read_b128 v[132:135], v16 offset:2176
    ds_read_b128 v[144:147], v16 offset:3712
    v_mfma_f32_16x16x32_bf16 v[192:195], v[20:23], v[80:83], 0
    v_cvt_pk_bf16_f32 v6, v168, v169
    v_cvt_pk_bf16_f32 v7, v170, v171
    v_mfma_f32_16x16x32_bf16 v[184:187], v[24:27], v[60:63], v[184:187]
    ds_read_b64 v[88:89], v15 offset:3200
    ds_read_b64 v[90:91], v15 offset:3208
    v_mfma_f32_16x16x32_bf16 v[188:191], v[24:27], v[64:67], v[188:191]
    ds_read_b128 v[124:127], v16 offset:1152
    ds_write_b64 v19, v[6:7] offset:2560
    v_mfma_f32_16x16x32_bf16 v[192:195], v[24:27], v[76:79], v[192:195]
    v_cvt_pk_bf16_f32 v4, v172, v173
    v_cvt_pk_bf16_f32 v5, v174, v175
    v_mfma_f32_16x16x32_bf16 v[184:187], v[28:31], v[56:59], v[184:187]
    ds_read_b128 v[140:143], v16 offset:3200
    ds_read_b64 v[92:93], v15 offset:2688
    v_mfma_f32_16x16x32_bf16 v[188:191], v[28:31], v[60:63], v[188:191]
    ds_read_b64 v[94:95], v15 offset:2696
    ds_write_b64 v19, v[4:5] offset:3072
    v_mfma_f32_16x16x32_bf16 v[192:195], v[28:31], v[72:75], v[192:195]
    v_cvt_pk_bf16_f32 v6, v176, v177
    v_cvt_pk_bf16_f32 v7, v178, v179
    v_mfma_f32_16x16x32_bf16 v[184:187], v[32:35], v[52:55], v[184:187]
    ds_read_b128 v[120:123], v16 offset:640
    ds_read_b128 v[136:139], v16 offset:2688
    v_mfma_f32_16x16x32_bf16 v[188:191], v[32:35], v[56:59], v[188:191]
    ds_read_b64 v[96:97], v15 offset:2176
    ds_write_b64 v19, v[6:7] offset:3584
    v_mfma_f32_16x16x32_bf16 v[192:195], v[32:35], v[68:71], v[192:195]
    ds_read_b64 v[98:99], v15 offset:2184
    ds_read_b64 v[100:101], v15 offset:1664
    v_mfma_f32_16x16x32_bf16 v[188:191], v[36:39], v[52:55], v[188:191]
    ds_read_b64 v[102:103], v15 offset:1672
    ds_read_b64 v[104:105], v15 offset:1152
    v_mfma_f32_16x16x32_bf16 v[192:195], v[36:39], v[64:67], v[192:195]
    ds_read_b64 v[106:107], v15 offset:1160
    ds_read_b64 v[108:109], v15 offset:640
    v_mfma_f32_16x16x32_bf16 v[192:195], v[40:43], v[60:63], v[192:195]
    ds_read_b64 v[110:111], v15 offset:648
    ds_read_b64 v[112:113], v15 offset:128
    v_mfma_f32_16x16x32_bf16 v[192:195], v[44:47], v[56:59], v[192:195]
    ds_read_b64 v[114:115], v15 offset:136
    v_mfma_f32_16x16x32_bf16 v[192:195], v[48:51], v[52:55], v[192:195]
    s_waitcnt lgkmcnt(0)
    s_barrier
    s_waitcnt lgkmcnt(0)
    v_mfma_f32_16x16x32_bf16 v[180:183], v[84:87], v[116:119], v[180:183]
    ds_read_b64 v[20:21], v15 offset:3648
    ds_read_b64 v[22:23], v15 offset:3656
    v_mfma_f32_16x16x32_bf16 v[184:187], v[84:87], v[128:131], v[184:187]
    ds_read_b128 v[52:55], v16 offset:64
    v_mfma_f32_16x16x32_bf16 v[188:191], v[84:87], v[132:135], v[188:191]
    ds_read_b128 v[64:67], v16 offset:1600
    ds_read_b128 v[68:71], v16 offset:2112
    v_mfma_f32_16x16x32_bf16 v[192:195], v[84:87], v[144:147], v[192:195]
    ds_read_b128 v[80:83], v16 offset:3648
    v_mfma_f32_16x16x32_bf16 v[184:187], v[88:91], v[124:127], v[184:187]
    ds_read_b64 v[24:25], v15 offset:3136
    ds_read_b64 v[26:27], v15 offset:3144
    v_mfma_f32_16x16x32_bf16 v[188:191], v[88:91], v[128:131], v[188:191]
    ds_read_b128 v[60:63], v16 offset:1088
    v_mfma_f32_16x16x32_bf16 v[192:195], v[88:91], v[140:143], v[192:195]
    ds_read_b128 v[76:79], v16 offset:3136
    v_mfma_f32_16x16x32_bf16 v[184:187], v[92:95], v[120:123], v[184:187]
    ds_read_b64 v[28:29], v15 offset:2624
    ds_read_b64 v[30:31], v15 offset:2632
    v_mfma_f32_16x16x32_bf16 v[188:191], v[92:95], v[124:127], v[188:191]
    ds_read_b128 v[56:59], v16 offset:576
    v_mfma_f32_16x16x32_bf16 v[192:195], v[92:95], v[136:139], v[192:195]
    ds_read_b128 v[72:75], v16 offset:2624
    ds_read_b64 v[32:33], v15 offset:2112
    v_mfma_f32_16x16x32_bf16 v[184:187], v[96:99], v[116:119], v[184:187]
    ds_read_b64 v[34:35], v15 offset:2120
    v_mfma_f32_16x16x32_bf16 v[188:191], v[96:99], v[120:123], v[188:191]
    ds_read_b64 v[36:37], v15 offset:1600
    v_mfma_f32_16x16x32_bf16 v[192:195], v[96:99], v[132:135], v[192:195]
    ds_read_b64 v[38:39], v15 offset:1608
    ds_read_b64 v[40:41], v15 offset:1088
    v_mfma_f32_16x16x32_bf16 v[188:191], v[100:103], v[116:119], v[188:191]
    ds_read_b64 v[42:43], v15 offset:1096
    v_mfma_f32_16x16x32_bf16 v[192:195], v[100:103], v[128:131], v[192:195]
    ds_read_b64 v[44:45], v15 offset:576
    ds_read_b64 v[46:47], v15 offset:584
    v_mfma_f32_16x16x32_bf16 v[192:195], v[104:107], v[124:127], v[192:195]
    ds_read_b64 v[48:49], v15 offset:64
    v_mfma_f32_16x16x32_bf16 v[192:195], v[108:111], v[120:123], v[192:195]
    ds_read_b64 v[50:51], v15 offset:72
    v_mfma_f32_16x16x32_bf16 v[192:195], v[112:115], v[116:119], v[192:195]
    s_waitcnt lgkmcnt(0)
    v_mfma_f32_16x16x32_bf16 v[180:183], v[20:23], v[52:55], v[180:183]
    ds_read_b64 v[84:85], v15 offset:3584
    ds_read_b64 v[86:87], v15 offset:3592
    v_mfma_f32_16x16x32_bf16 v[184:187], v[20:23], v[64:67], v[184:187]
    ds_read_b128 v[116:119], v16 offset:0
    v_mfma_f32_16x16x32_bf16 v[188:191], v[20:23], v[68:71], v[188:191]
    ds_read_b128 v[128:131], v16 offset:1536
    ds_read_b128 v[132:135], v16 offset:2048
    v_mfma_f32_16x16x32_bf16 v[192:195], v[20:23], v[80:83], v[192:195]
    ds_read_b128 v[144:147], v16 offset:3584
    v_mfma_f32_16x16x32_bf16 v[184:187], v[24:27], v[60:63], v[184:187]
    ds_read_b64 v[88:89], v15 offset:3072
    ds_read_b64 v[90:91], v15 offset:3080
    v_mfma_f32_16x16x32_bf16 v[188:191], v[24:27], v[64:67], v[188:191]
    ds_read_b128 v[124:127], v16 offset:1024
    v_mfma_f32_16x16x32_bf16 v[192:195], v[24:27], v[76:79], v[192:195]
    ds_read_b128 v[140:143], v16 offset:3072
    v_mfma_f32_16x16x32_bf16 v[184:187], v[28:31], v[56:59], v[184:187]
    ds_read_b64 v[92:93], v15 offset:2560
    ds_read_b64 v[94:95], v15 offset:2568
    v_mfma_f32_16x16x32_bf16 v[188:191], v[28:31], v[60:63], v[188:191]
    ds_read_b128 v[120:123], v16 offset:512
    v_mfma_f32_16x16x32_bf16 v[192:195], v[28:31], v[72:75], v[192:195]
    ds_read_b128 v[136:139], v16 offset:2560
    ds_read_b64 v[96:97], v15 offset:2048
    v_mfma_f32_16x16x32_bf16 v[184:187], v[32:35], v[52:55], v[184:187]
    ds_read_b64 v[98:99], v15 offset:2056
    v_mfma_f32_16x16x32_bf16 v[188:191], v[32:35], v[56:59], v[188:191]
    ds_read_b64 v[100:101], v15 offset:1536
    v_mfma_f32_16x16x32_bf16 v[192:195], v[32:35], v[68:71], v[192:195]
    ds_read_b64 v[102:103], v15 offset:1544
    ds_read_b64 v[104:105], v15 offset:1024
    v_mfma_f32_16x16x32_bf16 v[188:191], v[36:39], v[52:55], v[188:191]
    ds_read_b64 v[106:107], v15 offset:1032
    v_mfma_f32_16x16x32_bf16 v[192:195], v[36:39], v[64:67], v[192:195]
    ds_read_b64 v[108:109], v15 offset:512
    ds_read_b64 v[110:111], v15 offset:520
    v_mfma_f32_16x16x32_bf16 v[192:195], v[40:43], v[60:63], v[192:195]
    ds_read_b64 v[112:113], v15 offset:0
    v_mfma_f32_16x16x32_bf16 v[192:195], v[44:47], v[56:59], v[192:195]
    ds_read_b64 v[114:115], v15 offset:8
    v_mfma_f32_16x16x32_bf16 v[192:195], v[48:51], v[52:55], v[192:195]
    s_waitcnt lgkmcnt(0)
    v_mfma_f32_16x16x32_bf16 v[180:183], v[84:87], v[116:119], v[180:183]
    ds_read_b64 v[24:25], v198
    v_mfma_f32_16x16x32_bf16 v[184:187], v[84:87], v[128:131], v[184:187]
    v_mfma_f32_16x16x32_bf16 v[188:191], v[84:87], v[132:135], v[188:191]
    v_mfma_f32_16x16x32_bf16 v[192:195], v[84:87], v[144:147], v[192:195]
    v_mfma_f32_16x16x32_bf16 v[184:187], v[88:91], v[124:127], v[184:187]
    ds_read_b64 v[26:27], v198 offset:16640
    v_mfma_f32_16x16x32_bf16 v[188:191], v[88:91], v[128:131], v[188:191]
    v_mfma_f32_16x16x32_bf16 v[192:195], v[88:91], v[140:143], v[192:195]
    v_mfma_f32_16x16x32_bf16 v[184:187], v[92:95], v[120:123], v[184:187]
    v_mfma_f32_16x16x32_bf16 v[188:191], v[92:95], v[124:127], v[188:191]
    ds_read_b128 v[28:31], v199
    v_mfma_f32_16x16x32_bf16 v[192:195], v[92:95], v[136:139], v[192:195]
    v_mfma_f32_16x16x32_bf16 v[184:187], v[96:99], v[116:119], v[184:187]
    v_mfma_f32_16x16x32_bf16 v[188:191], v[96:99], v[120:123], v[188:191]
    v_mfma_f32_16x16x32_bf16 v[192:195], v[96:99], v[132:135], v[192:195]
    ds_read_b128 v[32:35], v199 offset:8192
    v_mfma_f32_16x16x32_bf16 v[188:191], v[100:103], v[116:119], v[188:191]
    v_mfma_f32_16x16x32_bf16 v[192:195], v[100:103], v[128:131], v[192:195]
    v_mfma_f32_16x16x32_bf16 v[192:195], v[104:107], v[124:127], v[192:195]
    v_mfma_f32_16x16x32_bf16 v[192:195], v[108:111], v[120:123], v[192:195]
    v_mfma_f32_16x16x32_bf16 v[192:195], v[112:115], v[116:119], v[192:195]
    s_branch L_C2_DONE
L_C2_E1:
    s_waitcnt lgkmcnt(0)
    v_mfma_f32_16x16x32_bf16 v[148:151], v[84:87], v[116:119], v[148:151]
    v_mfma_f32_16x16x32_bf16 v[152:155], v[84:87], v[120:123], v[152:155]
    ds_read_b64 v[20:21], v15 offset:3776
    v_mfma_f32_16x16x32_bf16 v[156:159], v[84:87], v[124:127], v[156:159]
    ds_read_b64 v[22:23], v15 offset:3784
    v_mfma_f32_16x16x32_bf16 v[160:163], v[84:87], v[128:131], v[160:163]
    ds_read_b128 v[56:59], v16 offset:704
    v_mfma_f32_16x16x32_bf16 v[164:167], v[84:87], v[132:135], v[164:167]
    ds_read_b128 v[60:63], v16 offset:1216
    v_mfma_f32_16x16x32_bf16 v[168:171], v[84:87], v[136:139], v[168:171]
    ds_read_b128 v[72:75], v16 offset:2752
    v_cvt_pk_bf16_f32 v4, v148, v149
    v_cvt_pk_bf16_f32 v5, v150, v151
    v_mfma_f32_16x16x32_bf16 v[172:175], v[84:87], v[140:143], v[172:175]
    ds_read_b128 v[76:79], v16 offset:3264
    v_mfma_f32_16x16x32_bf16 v[176:179], v[84:87], v[144:147], v[176:179]
    ds_read_b64 v[24:25], v15 offset:3264
    ds_write_b64 v19, v[4:5] offset:0
    v_mfma_f32_16x16x32_bf16 v[152:155], v[88:91], v[116:119], v[152:155]
    ds_read_b64 v[26:27], v15 offset:3272
    v_mfma_f32_16x16x32_bf16 v[156:159], v[88:91], v[120:123], v[156:159]
    ds_read_b128 v[52:55], v16 offset:192
    v_mfma_f32_16x16x32_bf16 v[160:163], v[88:91], v[124:127], v[160:163]
    ds_read_b128 v[68:71], v16 offset:2240
    v_mfma_f32_16x16x32_bf16 v[164:167], v[88:91], v[128:131], v[164:167]
    ds_read_b64 v[28:29], v15 offset:2752
    v_mfma_f32_16x16x32_bf16 v[168:171], v[88:91], v[132:135], v[168:171]
    ds_read_b64 v[30:31], v15 offset:2760
    v_mfma_f32_16x16x32_bf16 v[172:175], v[88:91], v[136:139], v[172:175]
    ds_read_b128 v[64:67], v16 offset:1728
    v_cvt_pk_bf16_f32 v6, v152, v153
    v_cvt_pk_bf16_f32 v7, v154, v155
    v_mfma_f32_16x16x32_bf16 v[176:179], v[88:91], v[140:143], v[176:179]
    ds_read_b64 v[32:33], v15 offset:2240
    v_mfma_f32_16x16x32_bf16 v[156:159], v[92:95], v[116:119], v[156:159]
    ds_read_b64 v[34:35], v15 offset:2248
    ds_write_b64 v19, v[6:7] offset:512
    v_mfma_f32_16x16x32_bf16 v[160:163], v[92:95], v[120:123], v[160:163]
    ds_read_b64 v[36:37], v15 offset:1728
    v_mfma_f32_16x16x32_bf16 v[164:167], v[92:95], v[124:127], v[164:167]
    ds_read_b64 v[38:39], v15 offset:1736
    v_mfma_f32_16x16x32_bf16 v[168:171], v[92:95], v[128:131], v[168:171]
    ds_read_b64 v[40:41], v15 offset:1216
    v_mfma_f32_16x16x32_bf16 v[172:175], v[92:95], v[132:135], v[172:175]
    ds_read_b64 v[42:43], v15 offset:1224
    v_mfma_f32_16x16x32_bf16 v[176:179], v[92:95], v[136:139], v[176:179]
    ds_read_b64 v[44:45], v15 offset:704
    v_cvt_pk_bf16_f32 v4, v156, v157
    v_cvt_pk_bf16_f32 v5, v158, v159
    v_mfma_f32_16x16x32_bf16 v[160:163], v[96:99], v[116:119], v[160:163]
    ds_read_b64 v[46:47], v15 offset:712
    v_mfma_f32_16x16x32_bf16 v[164:167], v[96:99], v[120:123], v[164:167]
    ds_write_b64 v19, v[4:5] offset:1024
    v_mfma_f32_16x16x32_bf16 v[168:171], v[96:99], v[124:127], v[168:171]
    v_mfma_f32_16x16x32_bf16 v[172:175], v[96:99], v[128:131], v[172:175]
    v_mfma_f32_16x16x32_bf16 v[176:179], v[96:99], v[132:135], v[176:179]
    v_mfma_f32_16x16x32_bf16 v[164:167], v[100:103], v[116:119], v[164:167]
    s_nop 0
    v_cvt_pk_bf16_f32 v6, v160, v161
    v_cvt_pk_bf16_f32 v7, v162, v163
    v_mfma_f32_16x16x32_bf16 v[168:171], v[100:103], v[120:123], v[168:171]
    v_mfma_f32_16x16x32_bf16 v[172:175], v[100:103], v[124:127], v[172:175]
    ds_write_b64 v19, v[6:7] offset:1536
    v_mfma_f32_16x16x32_bf16 v[176:179], v[100:103], v[128:131], v[176:179]
    v_mfma_f32_16x16x32_bf16 v[168:171], v[104:107], v[116:119], v[168:171]
    v_mfma_f32_16x16x32_bf16 v[172:175], v[104:107], v[120:123], v[172:175]
    v_cvt_pk_bf16_f32 v4, v164, v165
    v_cvt_pk_bf16_f32 v5, v166, v167
    v_mfma_f32_16x16x32_bf16 v[176:179], v[104:107], v[124:127], v[176:179]
    v_mfma_f32_16x16x32_bf16 v[172:175], v[108:111], v[116:119], v[172:175]
    ds_write_b64 v19, v[4:5] offset:2048
    v_mfma_f32_16x16x32_bf16 v[176:179], v[108:111], v[120:123], v[176:179]
    v_mfma_f32_16x16x32_bf16 v[176:179], v[112:115], v[116:119], v[176:179]
    s_waitcnt lgkmcnt(0)
    v_mfma_f32_16x16x32_bf16 v[180:183], v[20:23], v[56:59], 0
    ds_read_b64 v[84:85], v15 offset:3712
    ds_read_b64 v[86:87], v15 offset:3720
    v_mfma_f32_16x16x32_bf16 v[184:187], v[20:23], v[60:63], 0
    ds_read_b128 v[120:123], v16 offset:640
    ds_read_b128 v[124:127], v16 offset:1152
    v_mfma_f32_16x16x32_bf16 v[188:191], v[20:23], v[72:75], 0
    ds_read_b128 v[136:139], v16 offset:2688
    ds_read_b128 v[140:143], v16 offset:3200
    v_mfma_f32_16x16x32_bf16 v[192:195], v[20:23], v[76:79], 0
    v_cvt_pk_bf16_f32 v6, v168, v169
    v_cvt_pk_bf16_f32 v7, v170, v171
    v_mfma_f32_16x16x32_bf16 v[180:183], v[24:27], v[52:55], v[180:183]
    ds_read_b64 v[88:89], v15 offset:3200
    v_mfma_f32_16x16x32_bf16 v[184:187], v[24:27], v[56:59], v[184:187]
    ds_read_b64 v[90:91], v15 offset:3208
    ds_read_b128 v[116:119], v16 offset:128
    v_mfma_f32_16x16x32_bf16 v[188:191], v[24:27], v[68:71], v[188:191]
    ds_write_b64 v19, v[6:7] offset:2560
    v_cvt_pk_bf16_f32 v4, v172, v173
    v_mfma_f32_16x16x32_bf16 v[192:195], v[24:27], v[72:75], v[192:195]
    v_cvt_pk_bf16_f32 v5, v174, v175
    ds_read_b128 v[132:135], v16 offset:2176
    v_mfma_f32_16x16x32_bf16 v[184:187], v[28:31], v[52:55], v[184:187]
    ds_read_b64 v[92:93], v15 offset:2688
    v_mfma_f32_16x16x32_bf16 v[188:191], v[28:31], v[64:67], v[188:191]
    ds_read_b64 v[94:95], v15 offset:2696
    ds_write_b64 v19, v[4:5] offset:3072
    v_mfma_f32_16x16x32_bf16 v[192:195], v[28:31], v[68:71], v[192:195]
    v_cvt_pk_bf16_f32 v6, v176, v177
    v_cvt_pk_bf16_f32 v7, v178, v179
    v_mfma_f32_16x16x32_bf16 v[188:191], v[32:35], v[60:63], v[188:191]
    ds_read_b128 v[128:131], v16 offset:1664
    ds_read_b64 v[96:97], v15 offset:2176
    v_mfma_f32_16x16x32_bf16 v[192:195], v[32:35], v[64:67], v[192:195]
    ds_read_b64 v[98:99], v15 offset:2184
    v_mfma_f32_16x16x32_bf16 v[188:191], v[36:39], v[56:59], v[188:191]
    ds_write_b64 v19, v[6:7] offset:3584
    ds_read_b64 v[100:101], v15 offset:1664
    v_mfma_f32_16x16x32_bf16 v[192:195], v[36:39], v[60:63], v[192:195]
    ds_read_b64 v[102:103], v15 offset:1672
    ds_read_b64 v[104:105], v15 offset:1152
    v_mfma_f32_16x16x32_bf16 v[188:191], v[40:43], v[52:55], v[188:191]
    ds_read_b64 v[106:107], v15 offset:1160
    ds_read_b64 v[108:109], v15 offset:640
    v_mfma_f32_16x16x32_bf16 v[192:195], v[40:43], v[56:59], v[192:195]
    ds_read_b64 v[110:111], v15 offset:648
    v_mfma_f32_16x16x32_bf16 v[192:195], v[44:47], v[52:55], v[192:195]
    s_waitcnt lgkmcnt(0)
    s_barrier
    s_waitcnt lgkmcnt(0)
    v_mfma_f32_16x16x32_bf16 v[180:183], v[84:87], v[120:123], v[180:183]
    ds_read_b64 v[20:21], v15 offset:3648
    ds_read_b64 v[22:23], v15 offset:3656
    v_mfma_f32_16x16x32_bf16 v[184:187], v[84:87], v[124:127], v[184:187]
    ds_read_b128 v[56:59], v16 offset:576
    v_mfma_f32_16x16x32_bf16 v[188:191], v[84:87], v[136:139], v[188:191]
    ds_read_b128 v[60:63], v16 offset:1088
    v_mfma_f32_16x16x32_bf16 v[192:195], v[84:87], v[140:143], v[192:195]
    ds_read_b128 v[72:75], v16 offset:2624
    v_mfma_f32_16x16x32_bf16 v[180:183], v[88:91], v[116:119], v[180:183]
    ds_read_b128 v[76:79], v16 offset:3136
    ds_read_b64 v[24:25], v15 offset:3136
    v_mfma_f32_16x16x32_bf16 v[184:187], v[88:91], v[120:123], v[184:187]
    ds_read_b64 v[26:27], v15 offset:3144
    v_mfma_f32_16x16x32_bf16 v[188:191], v[88:91], v[132:135], v[188:191]
    ds_read_b128 v[52:55], v16 offset:64
    v_mfma_f32_16x16x32_bf16 v[192:195], v[88:91], v[136:139], v[192:195]
    ds_read_b128 v[68:71], v16 offset:2112
    v_mfma_f32_16x16x32_bf16 v[184:187], v[92:95], v[116:119], v[184:187]
    ds_read_b64 v[28:29], v15 offset:2624
    ds_read_b64 v[30:31], v15 offset:2632
    v_mfma_f32_16x16x32_bf16 v[188:191], v[92:95], v[128:131], v[188:191]
    ds_read_b128 v[64:67], v16 offset:1600
    v_mfma_f32_16x16x32_bf16 v[192:195], v[92:95], v[132:135], v[192:195]
    ds_read_b64 v[32:33], v15 offset:2112
    v_mfma_f32_16x16x32_bf16 v[188:191], v[96:99], v[124:127], v[188:191]
    ds_read_b64 v[34:35], v15 offset:2120
    v_mfma_f32_16x16x32_bf16 v[192:195], v[96:99], v[128:131], v[192:195]
    ds_read_b64 v[36:37], v15 offset:1600
    ds_read_b64 v[38:39], v15 offset:1608
    v_mfma_f32_16x16x32_bf16 v[188:191], v[100:103], v[120:123], v[188:191]
    ds_read_b64 v[40:41], v15 offset:1088
    v_mfma_f32_16x16x32_bf16 v[192:195], v[100:103], v[124:127], v[192:195]
    ds_read_b64 v[42:43], v15 offset:1096
    v_mfma_f32_16x16x32_bf16 v[188:191], v[104:107], v[116:119], v[188:191]
    ds_read_b64 v[44:45], v15 offset:576
    v_mfma_f32_16x16x32_bf16 v[192:195], v[104:107], v[120:123], v[192:195]
    ds_read_b64 v[46:47], v15 offset:584
    v_mfma_f32_16x16x32_bf16 v[192:195], v[108:111], v[116:119], v[192:195]
    s_waitcnt lgkmcnt(0)
    v_mfma_f32_16x16x32_bf16 v[180:183], v[20:23], v[56:59], v[180:183]
    ds_read_b64 v[84:85], v15 offset:3584
    ds_read_b64 v[86:87], v15 offset:3592
    v_mfma_f32_16x16x32_bf16 v[184:187], v[20:23], v[60:63], v[184:187]
    ds_read_b128 v[120:123], v16 offset:512
    v_mfma_f32_16x16x32_bf16 v[188:191], v[20:23], v[72:75], v[188:191]
    ds_read_b128 v[124:127], v16 offset:1024
    v_mfma_f32_16x16x32_bf16 v[192:195], v[20:23], v[76:79], v[192:195]
    ds_read_b128 v[136:139], v16 offset:2560
    v_mfma_f32_16x16x32_bf16 v[180:183], v[24:27], v[52:55], v[180:183]
    ds_read_b128 v[140:143], v16 offset:3072
    ds_read_b64 v[88:89], v15 offset:3072
    v_mfma_f32_16x16x32_bf16 v[184:187], v[24:27], v[56:59], v[184:187]
    ds_read_b64 v[90:91], v15 offset:3080
    v_mfma_f32_16x16x32_bf16 v[188:191], v[24:27], v[68:71], v[188:191]
    ds_read_b128 v[116:119], v16 offset:0
    v_mfma_f32_16x16x32_bf16 v[192:195], v[24:27], v[72:75], v[192:195]
    ds_read_b128 v[132:135], v16 offset:2048
    v_mfma_f32_16x16x32_bf16 v[184:187], v[28:31], v[52:55], v[184:187]
    ds_read_b64 v[92:93], v15 offset:2560
    ds_read_b64 v[94:95], v15 offset:2568
    v_mfma_f32_16x16x32_bf16 v[188:191], v[28:31], v[64:67], v[188:191]
    ds_read_b128 v[128:131], v16 offset:1536
    v_mfma_f32_16x16x32_bf16 v[192:195], v[28:31], v[68:71], v[192:195]
    ds_read_b64 v[96:97], v15 offset:2048
    v_mfma_f32_16x16x32_bf16 v[188:191], v[32:35], v[60:63], v[188:191]
    ds_read_b64 v[98:99], v15 offset:2056
    v_mfma_f32_16x16x32_bf16 v[192:195], v[32:35], v[64:67], v[192:195]
    ds_read_b64 v[100:101], v15 offset:1536
    ds_read_b64 v[102:103], v15 offset:1544
    v_mfma_f32_16x16x32_bf16 v[188:191], v[36:39], v[56:59], v[188:191]
    ds_read_b64 v[104:105], v15 offset:1024
    v_mfma_f32_16x16x32_bf16 v[192:195], v[36:39], v[60:63], v[192:195]
    ds_read_b64 v[106:107], v15 offset:1032
    v_mfma_f32_16x16x32_bf16 v[188:191], v[40:43], v[52:55], v[188:191]
    ds_read_b64 v[108:109], v15 offset:512
    v_mfma_f32_16x16x32_bf16 v[192:195], v[40:43], v[56:59], v[192:195]
    ds_read_b64 v[110:111], v15 offset:520
    v_mfma_f32_16x16x32_bf16 v[192:195], v[44:47], v[52:55], v[192:195]
    s_waitcnt lgkmcnt(0)
    v_mfma_f32_16x16x32_bf16 v[180:183], v[84:87], v[120:123], v[180:183]
    ds_read_b64 v[24:25], v198
    v_mfma_f32_16x16x32_bf16 v[184:187], v[84:87], v[124:127], v[184:187]
    v_mfma_f32_16x16x32_bf16 v[188:191], v[84:87], v[136:139], v[188:191]
    v_mfma_f32_16x16x32_bf16 v[192:195], v[84:87], v[140:143], v[192:195]
    v_mfma_f32_16x16x32_bf16 v[180:183], v[88:91], v[116:119], v[180:183]
    ds_read_b64 v[26:27], v198 offset:16640
    v_mfma_f32_16x16x32_bf16 v[184:187], v[88:91], v[120:123], v[184:187]
    v_mfma_f32_16x16x32_bf16 v[188:191], v[88:91], v[132:135], v[188:191]
    v_mfma_f32_16x16x32_bf16 v[192:195], v[88:91], v[136:139], v[192:195]
    v_mfma_f32_16x16x32_bf16 v[184:187], v[92:95], v[116:119], v[184:187]
    ds_read_b128 v[28:31], v199
    v_mfma_f32_16x16x32_bf16 v[188:191], v[92:95], v[128:131], v[188:191]
    v_mfma_f32_16x16x32_bf16 v[192:195], v[92:95], v[132:135], v[192:195]
    v_mfma_f32_16x16x32_bf16 v[188:191], v[96:99], v[124:127], v[188:191]
    v_mfma_f32_16x16x32_bf16 v[192:195], v[96:99], v[128:131], v[192:195]
    ds_read_b128 v[32:35], v199 offset:8192
    v_mfma_f32_16x16x32_bf16 v[188:191], v[100:103], v[120:123], v[188:191]
    v_mfma_f32_16x16x32_bf16 v[192:195], v[100:103], v[124:127], v[192:195]
    v_mfma_f32_16x16x32_bf16 v[188:191], v[104:107], v[116:119], v[188:191]
    v_mfma_f32_16x16x32_bf16 v[192:195], v[104:107], v[120:123], v[192:195]
    v_mfma_f32_16x16x32_bf16 v[192:195], v[108:111], v[116:119], v[192:195]
L_C2_DONE:
    s_nop 2
    ds_write_b128 v196, v[180:183] offset:0
    ds_write_b128 v196, v[184:187] offset:1024
    s_nop 0
    ds_write_b128 v196, v[188:191] offset:2048
    s_nop 0
    ds_write_b128 v196, v[192:195] offset:3072
    v_mov_b32 v8, 163808
    v_mov_b32 v9, 1
    v_mov_b32 v4, v197
    v_mov_b32 v7, v12
    s_waitcnt lgkmcnt(4)
    v_and_b32 v52, 0xffff0000, v25
    v_lshlrev_b32 v53, 16, v25
    v_and_b32 v54, 0xffff0000, v24
    v_lshlrev_b32 v55, 16, v24
    v_and_b32 v56, 0xffff0000, v27
    v_lshlrev_b32 v57, 16, v27
    v_and_b32 v58, 0xffff0000, v26
    v_lshlrev_b32 v59, 16, v26
    s_waitcnt lgkmcnt(0)
    s_mov_b64 exec, 1
    ds_add_u32 v8, v9 offset:8
L_SY_R:
    ds_read_b32 v10, v8 offset:8
    s_waitcnt lgkmcnt(0)
    v_cmp_gt_u32 vcc, 4, v10
    s_nop 4
    s_cbranch_vccnz L_SY_R
    s_mov_b64 exec, -1
    ds_read_b128 v[36:39], v4 offset:0
    ds_read_b128 v[40:43], v4 offset:4096
    ds_read_b128 v[44:47], v4 offset:8192
    ds_read_b128 v[48:51], v4 offset:12288
    s_waitcnt lgkmcnt(0)
    v_add_f32 v36, v36, v44
    v_add_f32 v40, v40, v48
    v_add_f32 v37, v37, v45
    v_add_f32 v41, v41, v49
    v_add_f32 v38, v38, v46
    v_add_f32 v42, v42, v50
    v_add_f32 v39, v39, v47
    v_add_f32 v43, v43, v51
    v_fmac_f32 v36, s10, v52
    v_fmac_f32 v40, s13, v56
    v_fmac_f32 v37, s10, v53
    v_fmac_f32 v41, s13, v57
    v_fmac_f32 v38, s10, v54
    v_fmac_f32 v42, s13, v58
    v_fmac_f32 v39, s10, v55
    v_fmac_f32 v43, s13, v59
    v_mul_f32 v36, v36, v56
    v_mul_f32 v36, v36, v28
    v_fmac_f32 v36, v40, v32
    v_mul_f32 v37, v37, v57
    v_mul_f32 v37, v37, v29
    v_fmac_f32 v37, v41, v33
    v_mul_f32 v38, v38, v58
    v_mul_f32 v38, v38, v30
    v_fmac_f32 v38, v42, v34
    v_mul_f32 v39, v39, v59
    v_mul_f32 v39, v39, v31
    v_fmac_f32 v39, v43, v35
    v_cvt_pk_bf16_f32 v68, v36, v37
    v_cvt_pk_bf16_f32 v69, v38, v39
    v_min_u32 v68, 0xfffffffe, v68
    v_min_u32 v69, 0xfffffffe, v69
    buffer_store_dwordx2 v[68:69], v7, s[28:31], 0 offen sc1
    s_branch L_FINAL
L_HELP:
    s_sub_u32 s14, s3, 4
    s_lshr_b32 s22, s14, 1
    s_add_u32 s22, s16, s22
    s_lshl_b32 s22, s22, 1
    s_and_b32 s23, s14, 1
    s_add_u32 s22, s22, s23
    s_mul_i32 s22, s22, 4224
    s_add_u32 s28, s64, s22
    s_addc_u32 s29, s65, 0
    s_and_b32 s29, s29, 0xffff
    s_mov_b32 s30, 4096
    s_mov_b32 s31, 0x00020000
    s_mul_i32 s33, s14, 16640
    s_add_u32 m0, s33, 0
    s_movk_i32 s36, 0
    buffer_load_dwordx4 v3, s[28:31], s36 offen sc1 lds
    s_add_u32 m0, s33, 1024
    s_movk_i32 s36, 1024
    buffer_load_dwordx4 v3, s[28:31], s36 offen sc1 lds
    s_add_u32 m0, s33, 2048
    s_movk_i32 s36, 2048
    buffer_load_dwordx4 v3, s[28:31], s36 offen sc1 lds
    s_add_u32 m0, s33, 3072
    s_movk_i32 s36, 3072
    buffer_load_dwordx4 v3, s[28:31], s36 offen sc1 lds
    s_add_u32 m0, s33, 8320
    s_movk_i32 s36, 0
    buffer_load_dwordx4 v4, s[28:31], s36 offen sc1 lds
    s_add_u32 m0, s33, 9344
    s_movk_i32 s36, 1024
    buffer_load_dwordx4 v4, s[28:31], s36 offen sc1 lds
    s_add_u32 m0, s33, 10368
    s_movk_i32 s36, 2048
    buffer_load_dwordx4 v4, s[28:31], s36 offen sc1 lds
    s_add_u32 m0, s33, 11392
    s_movk_i32 s36, 3072
    buffer_load_dwordx4 v4, s[28:31], s36 offen sc1 lds
    s_waitcnt vmcnt(0)
    s_barrier
    s_cmp_ge_u32 s3, 6
    s_cbranch_scc1 L_H67
    buffer_load_dwordx4 v[64:67], v3, s[24:27], 0 offen offset:0 sc1
    buffer_load_dwordx4 v[68:71], v3, s[24:27], 0 offen offset:16 sc1
    buffer_load_dwordx4 v[72:75], v3, s[24:27], 0 offen offset:1024 sc1
    buffer_load_dwordx4 v[76:79], v3, s[24:27], 0 offen offset:1040 sc1
    buffer_load_dwordx4 v[80:83], v3, s[24:27], 0 offen offset:2048 sc1
    buffer_load_dwordx4 v[84:87], v3, s[24:27], 0 offen offset:2064 sc1
    buffer_load_dwordx4 v[88:91], v3, s[24:27], 0 offen offset:3072 sc1
    buffer_load_dwordx4 v[92:95], v3, s[24:27], 0 offen offset:3088 sc1
    s_add_u32 m0, s34, 0
    s_movk_i32 s36, 0
    buffer_load_dwordx4 v3, s[24:27], s36 offen sc1 lds
    s_add_u32 m0, s34, 1024
    s_movk_i32 s36, 1024
    buffer_load_dwordx4 v3, s[24:27], s36 offen sc1 lds
    s_add_u32 m0, s34, 2048
    s_movk_i32 s36, 2048
    buffer_load_dwordx4 v3, s[24:27], s36 offen sc1 lds
    s_add_u32 m0, s34, 3072
    s_movk_i32 s36, 3072
    buffer_load_dwordx4 v3, s[24:27], s36 offen sc1 lds
    s_add_u32 m0, s34, 8320
    s_movk_i32 s36, 0
    buffer_load_dwordx4 v4, s[24:27], s36 offen sc1 lds
    s_add_u32 m0, s34, 9344
    s_movk_i32 s36, 1024
    buffer_load_dwordx4 v4, s[24:27], s36 offen sc1 lds
    s_add_u32 m0, s34, 10368
    s_movk_i32 s36, 2048
    buffer_load_dwordx4 v4, s[24:27], s36 offen sc1 lds
    s_add_u32 m0, s34, 11392
    s_movk_i32 s36, 3072
    buffer_load_dwordx4 v4, s[24:27], s36 offen sc1 lds
    s_mov_b64 exec, 0xff
    ds_write_b128 v5, v[8:11] offset:4096
    s_mov_b64 exec, -1
    s_waitcnt vmcnt(14)
    v_alignbit_b32 v96, v65, v64, 16
    v_alignbit_b32 v97, v66, v65, 16
    v_alignbit_b32 v98, v67, v66, 16
    v_alignbit_b32 v99, v68, v67, 16
    v_alignbit_b32 v100, v66, v65, 16
    v_alignbit_b32 v101, v67, v66, 16
    v_alignbit_b32 v102, v68, v67, 16
    v_alignbit_b32 v103, v69, v68, 16
    ds_write_b128 v18, v[96:99] offset:4160
    ds_write_b128 v18, v[100:103] offset:12480
    s_waitcnt vmcnt(12)
    v_alignbit_b32 v96, v73, v72, 16
    v_alignbit_b32 v97, v74, v73, 16
    v_alignbit_b32 v98, v75, v74, 16
    v_alignbit_b32 v99, v76, v75, 16
    v_alignbit_b32 v100, v74, v73, 16
    v_alignbit_b32 v101, v75, v74, 16
    v_alignbit_b32 v102, v76, v75, 16
    v_alignbit_b32 v103, v77, v76, 16
    ds_write_b128 v18, v[96:99] offset:5184
    ds_write_b128 v18, v[100:103] offset:13504
    s_waitcnt vmcnt(10)
    v_alignbit_b32 v96, v81, v80, 16
    v_alignbit_b32 v97, v82, v81, 16
    v_alignbit_b32 v98, v83, v82, 16
    v_alignbit_b32 v99, v84, v83, 16
    v_alignbit_b32 v100, v82, v81, 16
    v_alignbit_b32 v101, v83, v82, 16
    v_alignbit_b32 v102, v84, v83, 16
    v_alignbit_b32 v103, v85, v84, 16
    ds_write_b128 v18, v[96:99] offset:6208
    ds_write_b128 v18, v[100:103] offset:14528
    s_waitcnt vmcnt(8)
    v_alignbit_b32 v96, v89, v88, 16
    v_alignbit_b32 v97, v90, v89, 16
    v_alignbit_b32 v98, v91, v90, 16
    v_alignbit_b32 v99, v92, v91, 16
    v_alignbit_b32 v100, v90, v89, 16
    v_alignbit_b32 v101, v91, v90, 16
    v_alignbit_b32 v102, v92, v91, 16
    v_alignbit_b32 v103, v93, v92, 16
    ds_write_b128 v18, v[96:99] offset:7232
    ds_write_b128 v18, v[100:103] offset:15552
    s_waitcnt vmcnt(0) lgkmcnt(0)
    v_mov_b32 v4, 163820
    v_mov_b32 v5, 1
    s_mov_b64 exec, 1
    ds_add_u32 v4, v5
    s_mov_b64 exec, -1
    s_branch L_HELP2
L_H67:
    v_mov_b32 v4, 163824
    ds_read_b32 v5, v4 offset:8
    s_add_u32 s24, s64, 8060928
    s_addc_u32 s25, s65, 0
    s_and_b32 s25, s25, 0xffff
    s_mov_b32 s26, 16384
    s_mov_b32 s27, 0x00020000
    s_sub_u32 s36, s3, 6
    s_lshl_b32 s36, s36, 13
    v_lshlrev_b32 v3, 4, v2
    v_add_u32 v6, s36, v3
    v_add_u32 v10, 4096, v6
    s_mov_b32 s21, 100000
L_G_POLL:
    buffer_load_dwordx4 v[20:23], v6, s[24:27], 0 offen offset:0 sc1
    buffer_load_dwordx4 v[24:27], v6, s[24:27], 0 offen offset:1024 sc1
    buffer_load_dwordx4 v[28:31], v6, s[24:27], 0 offen offset:2048 sc1
    buffer_load_dwordx4 v[32:35], v6, s[24:27], 0 offen offset:3072 sc1
    buffer_load_dwordx4 v[36:39], v10, s[24:27], 0 offen offset:0 sc1
    buffer_load_dwordx4 v[40:43], v10, s[24:27], 0 offen offset:1024 sc1
    buffer_load_dwordx4 v[44:47], v10, s[24:27], 0 offen offset:2048 sc1
    buffer_load_dwordx4 v[48:51], v10, s[24:27], 0 offen offset:3072 sc1
    s_waitcnt vmcnt(0) lgkmcnt(0)
    v_xor_b32 v7, v21, v5
    v_xor_b32 v8, v23, v5
    v_or_b32 v7, v7, v8
    v_xor_b32 v8, v25, v5
    v_or_b32 v7, v7, v8
    v_xor_b32 v8, v27, v5
    v_or_b32 v7, v7, v8
    v_xor_b32 v8, v29, v5
    v_or_b32 v7, v7, v8
    v_xor_b32 v8, v31, v5
    v_or_b32 v7, v7, v8
    v_xor_b32 v8, v33, v5
    v_or_b32 v7, v7, v8
    v_xor_b32 v8, v35, v5
    v_or_b32 v7, v7, v8
    v_xor_b32 v8, v37, v5
    v_or_b32 v7, v7, v8
    v_xor_b32 v8, v39, v5
    v_or_b32 v7, v7, v8
    v_xor_b32 v8, v41, v5
    v_or_b32 v7, v7, v8
    v_xor_b32 v8, v43, v5
    v_or_b32 v7, v7, v8
    v_xor_b32 v8, v45, v5
    v_or_b32 v7, v7, v8
    v_xor_b32 v8, v47, v5
    v_or_b32 v7, v7, v8
    v_xor_b32 v8, v49, v5
    v_or_b32 v7, v7, v8
    v_xor_b32 v8, v51, v5
    v_or_b32 v7, v7, v8
    v_cmp_ne_u32 vcc, 0, v7
    s_nop 4
    s_cbranch_vccz L_G_OK
    s_sub_u32 s21, s21, 1
    s_cmp_eq_u32 s21, 0
    s_cbranch_scc0 L_G_POLL
L_G_OK:
    s_lshr_b32 s36, s36, 1
    v_lshlrev_b32 v9, 3, v2
    v_add_u32 v9, s36, v9
    v_add_u32 v9, 127488, v9
    v_lshlrev_b32 v21, 16, v22
    v_and_b32 v23, 0xffff0000, v22
    v_and_b32 v22, 0xffff0000, v20
    v_lshlrev_b32 v20, 16, v20
    v_lshlrev_b32 v25, 16, v26
    v_and_b32 v27, 0xffff0000, v26
    v_and_b32 v26, 0xffff0000, v24
    v_lshlrev_b32 v24, 16, v24
    v_lshlrev_b32 v29, 16, v30
    v_and_b32 v31, 0xffff0000, v30
    v_and_b32 v30, 0xffff0000, v28
    v_lshlrev_b32 v28, 16, v28
    v_lshlrev_b32 v33, 16, v34
    v_and_b32 v35, 0xffff0000, v34
    v_and_b32 v34, 0xffff0000, v32
    v_lshlrev_b32 v32, 16, v32
    v_lshlrev_b32 v37, 16, v38
    v_and_b32 v39, 0xffff0000, v38
    v_and_b32 v38, 0xffff0000, v36
    v_lshlrev_b32 v36, 16, v36
    v_lshlrev_b32 v41, 16, v42
    v_and_b32 v43, 0xffff0000, v42
    v_and_b32 v42, 0xffff0000, v40
    v_lshlrev_b32 v40, 16, v40
    v_lshlrev_b32 v45, 16, v46
    v_and_b32 v47, 0xffff0000, v46
    v_and_b32 v46, 0xffff0000, v44
    v_lshlrev_b32 v44, 16, v44
    v_lshlrev_b32 v49, 16, v50
    v_and_b32 v51, 0xffff0000, v50
    v_and_b32 v50, 0xffff0000, v48
    v_lshlrev_b32 v48, 16, v48
    ds_write_b64 v9, v[20:21] offset:0
    ds_write_b64 v9, v[22:23] offset:8192
    ds_write_b64 v9, v[24:25] offset:512
    ds_write_b64 v9, v[26:27] offset:8704
    ds_write_b64 v9, v[28:29] offset:1024
    ds_write_b64 v9, v[30:31] offset:9216
    ds_write_b64 v9, v[32:33] offset:1536
    ds_write_b64 v9, v[34:35] offset:9728
    ds_write_b64 v9, v[36:37] offset:2048
    ds_write_b64 v9, v[38:39] offset:10240
    ds_write_b64 v9, v[40:41] offset:2560
    ds_write_b64 v9, v[42:43] offset:10752
    ds_write_b64 v9, v[44:45] offset:3072
    ds_write_b64 v9, v[46:47] offset:11264
    ds_write_b64 v9, v[48:49] offset:3584
    ds_write_b64 v9, v[50:51] offset:11776
L_GDONE:
    v_mov_b32 v8, 163808
    v_mov_b32 v9, 1
    s_waitcnt lgkmcnt(0)
    s_mov_b64 exec, 1
    ds_add_u32 v8, v9
    s_mov_b64 exec, -1
L_HELP2:
    s_waitcnt lgkmcnt(0)
    s_and_b32 s22, s16, 1
    s_lshl_b32 s22, s22, 4
    s_lshr_b32 s8, s8, s22
    s_lshl_b32 s8, s8, 16
    s_add_u32 s14, s16, 1
    s_and_b32 s22, s14, 1
    s_lshl_b32 s22, s22, 4
    s_lshr_b32 s9, s9, s22
    s_lshl_b32 s9, s9, 16
    s_and_b32 s22, s17, 1
    s_lshl_b32 s22, s22, 4
    s_lshr_b32 s10, s10, s22
    s_lshl_b32 s10, s10, 16
    s_and_b32 s22, s16, 1
    s_lshl_b32 s22, s22, 4
    s_lshr_b32 s11, s11, s22
    s_lshl_b32 s11, s11, 16
    s_add_u32 s14, s16, 1
    s_and_b32 s22, s14, 1
    s_lshl_b32 s22, s22, 4
    s_lshr_b32 s12, s12, s22
    s_lshl_b32 s12, s12, 16
    s_and_b32 s22, s17, 1
    s_lshl_b32 s22, s22, 4
    s_lshr_b32 s13, s13, s22
    s_lshl_b32 s13, s13, 16
    s_add_u32 s28, s64, 8388608
    s_addc_u32 s29, s65, 0
    s_and_b32 s29, s29, 0xffff
    s_mov_b32 s30, 2703360
    s_mov_b32 s31, 0x00020000
    v_and_b32 v1, 255, v0
    v_lshlrev_b32 v1, 4, v1
    v_add_u32 v8, 99840, v1
    v_sub_u32 v9, 4080, v1
    v_lshlrev_b32 v10, 1, v1
    v_add_u32 v10, 127488, v10
    ds_read_b128 v[20:23], v9 offset:0
    ds_read_b128 v[24:27], v9 offset:16640
    ds_read_b128 v[28:31], v9 offset:33280
    ds_read_b128 v[32:35], v9 offset:49920
    v_mov_b32 v11, 163808
L_GWAIT:
    ds_read_b32 v12, v11
    s_waitcnt lgkmcnt(0)
    v_cmp_gt_u32 vcc, 2, v12
    s_nop 4
    s_cbranch_vccnz L_GWAIT
    ds_read_b128 v[36:39], v10
    ds_read_b128 v[40:43], v10 offset:16
    ds_read_b128 v[44:47], v10 offset:8192
    ds_read_b128 v[48:51], v10 offset:8208
    s_add_u32 s14, s16, 1
    s_mul_i32 s47, s16, 4224
    s_mul_i32 s46, s14, 4224
    v_add_u32 v6, s47, v1
    v_add_u32 v7, s46, v1
    v_and_b32 v52, 0xffff0000, v23
    v_and_b32 v60, 0xffff0000, v27
    v_lshlrev_b32 v53, 16, v23
    v_lshlrev_b32 v61, 16, v27
    v_and_b32 v54, 0xffff0000, v22
    v_and_b32 v62, 0xffff0000, v26
    v_lshlrev_b32 v55, 16, v22
    v_lshlrev_b32 v63, 16, v26
    v_and_b32 v56, 0xffff0000, v21
    v_and_b32 v64, 0xffff0000, v25
    v_lshlrev_b32 v57, 16, v21
    v_lshlrev_b32 v65, 16, v25
    v_and_b32 v58, 0xffff0000, v20
    v_and_b32 v66, 0xffff0000, v24
    v_lshlrev_b32 v59, 16, v20
    v_lshlrev_b32 v67, 16, v24
    s_waitcnt lgkmcnt(0)
    v_mul_f32 v132, v36, v60
    v_mul_f32 v52, s8, v52
    v_mul_f32 v60, s11, v60
    v_mul_f32 v140, v44, v60
    v_fmac_f32 v140, v132, v52
    v_mul_f32 v133, v37, v61
    v_mul_f32 v53, s8, v53
    v_mul_f32 v61, s11, v61
    v_mul_f32 v141, v45, v61
    v_fmac_f32 v141, v133, v53
    v_mul_f32 v134, v38, v62
    v_mul_f32 v54, s8, v54
    v_mul_f32 v62, s11, v62
    v_mul_f32 v142, v46, v62
    v_fmac_f32 v142, v134, v54
    v_mul_f32 v135, v39, v63
    v_mul_f32 v55, s8, v55
    v_mul_f32 v63, s11, v63
    v_mul_f32 v143, v47, v63
    v_fmac_f32 v143, v135, v55
    v_mul_f32 v136, v40, v64
    v_mul_f32 v56, s8, v56
    v_mul_f32 v64, s11, v64
    v_mul_f32 v144, v48, v64
    v_fmac_f32 v144, v136, v56
    v_mul_f32 v137, v41, v65
    v_mul_f32 v57, s8, v57
    v_mul_f32 v65, s11, v65
    v_mul_f32 v145, v49, v65
    v_fmac_f32 v145, v137, v57
    v_mul_f32 v138, v42, v66
    v_mul_f32 v58, s8, v58
    v_mul_f32 v66, s11, v66
    v_mul_f32 v146, v50, v66
    v_fmac_f32 v146, v138, v58
    v_mul_f32 v139, v43, v67
    v_mul_f32 v59, s8, v59
    v_mul_f32 v67, s11, v67
    v_mul_f32 v147, v51, v67
    v_fmac_f32 v147, v139, v59
    v_and_b32 v52, 0xffff0000, v31
    v_and_b32 v60, 0xffff0000, v35
    v_lshlrev_b32 v53, 16, v31
    v_lshlrev_b32 v61, 16, v35
    v_and_b32 v54, 0xffff0000, v30
    v_and_b32 v62, 0xffff0000, v34
    v_lshlrev_b32 v55, 16, v30
    v_lshlrev_b32 v63, 16, v34
    v_and_b32 v56, 0xffff0000, v29
    v_and_b32 v64, 0xffff0000, v33
    v_lshlrev_b32 v57, 16, v29
    v_lshlrev_b32 v65, 16, v33
    v_and_b32 v58, 0xffff0000, v28
    v_and_b32 v66, 0xffff0000, v32
    v_lshlrev_b32 v59, 16, v28
    v_lshlrev_b32 v67, 16, v32
    v_mul_f32 v148, v36, v60
    v_mul_f32 v52, s9, v52
    v_mul_f32 v60, s12, v60
    v_mul_f32 v156, v44, v60
    v_fmac_f32 v156, v148, v52
    v_mul_f32 v149, v37, v61
    v_mul_f32 v53, s9, v53
    v_mul_f32 v61, s12, v61
    v_mul_f32 v157, v45, v61
    v_fmac_f32 v157, v149, v53
    v_mul_f32 v150, v38, v62
    v_mul_f32 v54, s9, v54
    v_mul_f32 v62, s12, v62
    v_mul_f32 v158, v46, v62
    v_fmac_f32 v158, v150, v54
    v_mul_f32 v151, v39, v63
    v_mul_f32 v55, s9, v55
    v_mul_f32 v63, s12, v63
    v_mul_f32 v159, v47, v63
    v_fmac_f32 v159, v151, v55
    v_mul_f32 v152, v40, v64
    v_mul_f32 v56, s9, v56
    v_mul_f32 v64, s12, v64
    v_mul_f32 v160, v48, v64
    v_fmac_f32 v160, v152, v56
    v_mul_f32 v153, v41, v65
    v_mul_f32 v57, s9, v57
    v_mul_f32 v65, s12, v65
    v_mul_f32 v161, v49, v65
    v_fmac_f32 v161, v153, v57
    v_mul_f32 v154, v42, v66
    v_mul_f32 v58, s9, v58
    v_mul_f32 v66, s12, v66
    v_mul_f32 v162, v50, v66
    v_fmac_f32 v162, v154, v58
    v_mul_f32 v155, v43, v67
    v_mul_f32 v59, s9, v59
    v_mul_f32 v67, s12, v67
    v_mul_f32 v163, v51, v67
    v_fmac_f32 v163, v155, v59
    s_setprio 1
    s_barrier
    ds_read_b128 v[20:23], v8 offset:0
    ds_read_b128 v[24:27], v8 offset:4608
    ds_read_b128 v[28:31], v8 offset:9216
    ds_read_b128 v[32:35], v8 offset:13824
    s_waitcnt lgkmcnt(2)
    v_lshlrev_b32 v52, 16, v20
    v_lshlrev_b32 v60, 16, v24
    v_and_b32 v53, 0xffff0000, v20
    v_and_b32 v61, 0xffff0000, v24
    v_lshlrev_b32 v54, 16, v21
    v_lshlrev_b32 v62, 16, v25
    v_and_b32 v55, 0xffff0000, v21
    v_and_b32 v63, 0xffff0000, v25
    v_lshlrev_b32 v56, 16, v22
    v_lshlrev_b32 v64, 16, v26
    v_and_b32 v57, 0xffff0000, v22
    v_and_b32 v65, 0xffff0000, v26
    v_lshlrev_b32 v58, 16, v23
    v_lshlrev_b32 v66, 16, v27
    v_and_b32 v59, 0xffff0000, v23
    v_and_b32 v67, 0xffff0000, v27
    v_fmac_f32 v140, v132, v52
    v_fmac_f32 v140, v44, v60
    v_fmac_f32 v141, v133, v53
    v_fmac_f32 v141, v45, v61
    v_fmac_f32 v142, v134, v54
    v_fmac_f32 v142, v46, v62
    v_fmac_f32 v143, v135, v55
    v_fmac_f32 v143, v47, v63
    v_fmac_f32 v144, v136, v56
    v_fmac_f32 v144, v48, v64
    v_fmac_f32 v145, v137, v57
    v_fmac_f32 v145, v49, v65
    v_fmac_f32 v146, v138, v58
    v_fmac_f32 v146, v50, v66
    v_fmac_f32 v147, v139, v59
    v_fmac_f32 v147, v51, v67
    v_cvt_pk_bf16_f32 v68, v140, v141
    v_cvt_pk_bf16_f32 v69, v142, v143
    v_cvt_pk_bf16_f32 v70, v144, v145
    v_cvt_pk_bf16_f32 v71, v146, v147
    v_min_u32 v68, 0xfffffffe, v68
    v_min_u32 v69, 0xfffffffe, v69
    v_min_u32 v70, 0xfffffffe, v70
    v_min_u32 v71, 0xfffffffe, v71
    buffer_store_dwordx4 v[68:71], v6, s[28:31], 0 offen sc1
    s_waitcnt lgkmcnt(0)
    v_lshlrev_b32 v52, 16, v28
    v_lshlrev_b32 v60, 16, v32
    v_and_b32 v53, 0xffff0000, v28
    v_and_b32 v61, 0xffff0000, v32
    v_lshlrev_b32 v54, 16, v29
    v_lshlrev_b32 v62, 16, v33
    v_and_b32 v55, 0xffff0000, v29
    v_and_b32 v63, 0xffff0000, v33
    v_lshlrev_b32 v56, 16, v30
    v_lshlrev_b32 v64, 16, v34
    v_and_b32 v57, 0xffff0000, v30
    v_and_b32 v65, 0xffff0000, v34
    v_lshlrev_b32 v58, 16, v31
    v_lshlrev_b32 v66, 16, v35
    v_and_b32 v59, 0xffff0000, v31
    v_and_b32 v67, 0xffff0000, v35
    v_fmac_f32 v156, v148, v52
    v_fmac_f32 v156, v44, v60
    v_fmac_f32 v157, v149, v53
    v_fmac_f32 v157, v45, v61
    v_fmac_f32 v158, v150, v54
    v_fmac_f32 v158, v46, v62
    v_fmac_f32 v159, v151, v55
    v_fmac_f32 v159, v47, v63
    v_fmac_f32 v160, v152, v56
    v_fmac_f32 v160, v48, v64
    v_fmac_f32 v161, v153, v57
    v_fmac_f32 v161, v49, v65
    v_fmac_f32 v162, v154, v58
    v_fmac_f32 v162, v50, v66
    v_fmac_f32 v163, v155, v59
    v_fmac_f32 v163, v51, v67
    v_cvt_pk_bf16_f32 v72, v156, v157
    v_cvt_pk_bf16_f32 v73, v158, v159
    v_cvt_pk_bf16_f32 v74, v160, v161
    v_cvt_pk_bf16_f32 v75, v162, v163
    v_min_u32 v72, 0xfffffffe, v72
    v_min_u32 v73, 0xfffffffe, v73
    v_min_u32 v74, 0xfffffffe, v74
    v_min_u32 v75, 0xfffffffe, v75
    buffer_store_dwordx4 v[72:75], v7, s[28:31], 0 offen sc1
    s_setprio 0
L_FINAL:
    v_and_b32 v2, 63, v0
    v_lshrrev_b32 v3, 3, v2
    v_mul_u32_u24 v3, 4224, v3
    v_and_b32 v4, 7, v2
    v_lshl_add_u32 v3, v4, 4, v3
    s_mul_i32 s22, s19, 337920
    s_lshl_b32 s23, s20, 7
    s_add_u32 s22, s22, s23
    v_add_u32 v3, s22, v3
    s_mov_b32 s12, s54
    s_and_b32 s13, s55, 0xffff
    s_mov_b32 s14, 2621440
    s_mov_b32 s15, 0x00020000
    v_mul_u32_u24 v5, 205, v0
    v_lshrrev_b32 v5, 11, v5
    v_mul_u32_u24 v6, 10, v5
    v_sub_u32 v6, v0, v6
    v_mul_u32_u24 v7, 1056, v6
    v_lshl_add_u32 v7, v5, 3, v7
    s_lshl_b32 s22, s20, 6
    v_lshl_add_u32 v8, v5, 2, s22
    v_mul_u32_u24 v8, 1280, v8
    s_mul_i32 s23, s19, 160
    v_lshl_add_u32 v9, v6, 4, s23
    v_add_u32 v8, v8, v9
    s_barrier
    v_lshrrev_b32 v10, 3, v2
    v_and_b32 v11, 7, v2
    s_mul_i32 s22, s19, 337920
    s_lshl_b32 s23, s20, 7
    s_add_u32 s22, s22, s23
    s_cmp_lt_u32 s3, 2
    s_cbranch_scc0 L_OT_B
    s_lshl_b32 s23, s3, 3
    v_add_u32 v10, s23, v10
    v_mul_u32_u24 v10, 5, v10
    v_add_u32 v10, 2, v10
    v_mov_b32 v12, v10
    s_branch L_OT_C
L_OT_B:
    s_sub_u32 s23, s3, 2
    s_lshl_b32 s23, s23, 3
    v_add_u32 v10, s23, v10
    s_cmp_lt_u32 s3, 4
    s_cselect_b32 s23, 48, 0
    v_add_u32 v12, s23, v10
    v_lshrrev_b32 v13, 2, v10
    v_and_b32 v14, 3, v10
    v_lshrrev_b32 v15, 1, v14
    v_add_u32 v14, v14, v15
    v_mad_u32_u24 v10, v13, 5, v14
    v_lshrrev_b32 v13, 2, v12
    v_and_b32 v14, 3, v12
    v_lshrrev_b32 v15, 1, v14
    v_add_u32 v14, v14, v15
    v_mad_u32_u24 v12, v13, 5, v14
L_OT_C:
    s_movk_i32 s23, 4224
    v_mul_lo_u32 v4, v10, s23
    v_lshl_add_u32 v4, v11, 4, v4
    v_add_u32 v4, s22, v4
    v_lshrrev_b32 v13, 3, v10
    v_and_b32 v14, 7, v10
    v_mul_u32_u24 v13, 1056, v13
    v_lshl_add_u32 v13, v14, 7, v13
    v_lshl_add_u32 v10, v11, 4, v13
    v_mul_lo_u32 v5, v12, s23
    v_lshl_add_u32 v5, v11, 4, v5
    v_add_u32 v5, s22, v5
    v_lshrrev_b32 v13, 3, v12
    v_and_b32 v14, 7, v12
    v_mul_u32_u24 v13, 1056, v13
    v_lshl_add_u32 v13, v14, 7, v13
    v_lshl_add_u32 v12, v11, 4, v13
    s_mov_b32 s21, 100000
    s_cmp_lt_u32 s3, 2
    s_cbranch_scc0 L_OT_POLL2
    buffer_load_dwordx4 v[48:51], v4, s[28:31], 0 offen sc1
    s_sleep 8
    buffer_load_dwordx4 v[52:55], v4, s[28:31], 0 offen sc1
    s_sleep 8
    buffer_load_dwordx4 v[56:59], v4, s[28:31], 0 offen sc1
L_OT_POLL1:
    s_waitcnt vmcnt(2)
    v_max_u32 v28, v48, v49
    v_max3_u32 v28, v28, v50, v51
    v_cmp_eq_u32 vcc, -1, v28
    s_nop 4
    s_cbranch_vccz L_OT_OK48
    buffer_load_dwordx4 v[48:51], v4, s[28:31], 0 offen sc1
    s_waitcnt vmcnt(2)
    v_max_u32 v28, v52, v53
    v_max3_u32 v28, v28, v54, v55
    v_cmp_eq_u32 vcc, -1, v28
    s_nop 4
    s_cbranch_vccz L_OT_OK52
    buffer_load_dwordx4 v[52:55], v4, s[28:31], 0 offen sc1
    s_waitcnt vmcnt(2)
    v_max_u32 v28, v56, v57
    v_max3_u32 v28, v28, v58, v59
    v_cmp_eq_u32 vcc, -1, v28
    s_nop 4
    s_cbranch_vccz L_OT_OK56
    buffer_load_dwordx4 v[56:59], v4, s[28:31], 0 offen sc1
    s_sub_u32 s21, s21, 1
    s_cmp_eq_u32 s21, 0
    s_cbranch_scc0 L_OT_POLL1
L_OT_OK48:
    ds_write_b128 v10, v[48:51]
    s_branch L_OT_W
L_OT_OK52:
    ds_write_b128 v10, v[52:55]
    s_branch L_OT_W
L_OT_OK56:
    ds_write_b128 v10, v[56:59]
    s_branch L_OT_W
L_OT_POLL2:
    buffer_load_dwordx4 v[16:19], v4, s[28:31], 0 offen sc1
    buffer_load_dwordx4 v[20:23], v5, s[28:31], 0 offen sc1
    s_waitcnt vmcnt(0)
    v_max_u32 v28, v16, v17
    v_max3_u32 v28, v28, v18, v19
    v_max3_u32 v28, v28, v20, v21
    v_max3_u32 v28, v28, v22, v23
    v_cmp_eq_u32 vcc, -1, v28
    s_nop 4
    s_cbranch_vccz L_OT_OK2
    s_sub_u32 s21, s21, 1
    s_cmp_eq_u32 s21, 0
    s_cbranch_scc0 L_OT_POLL2
L_OT_OK2:
    ds_write_b128 v10, v[16:19]
    ds_write_b128 v12, v[20:23]
L_OT_W:
    s_waitcnt lgkmcnt(0)
    s_barrier
    v_cmp_gt_u32 vcc, 160, v0
    s_nop 2
    s_and_saveexec_b64 s[22:23], vcc
    s_nop 0
    s_cbranch_execz L_FINISH
    ds_read_b64 v[16:17], v7 offset:0
    ds_read_b64 v[18:19], v7 offset:128
    ds_read_b64 v[20:21], v7 offset:256
    ds_read_b64 v[22:23], v7 offset:384
    ds_read_b64 v[24:25], v7 offset:512
    ds_read_b64 v[26:27], v7 offset:640
    ds_read_b64 v[28:29], v7 offset:768
    ds_read_b64 v[30:31], v7 offset:896
    s_mov_b32 s24, 0x05040100
    s_mov_b32 s25, 0x07060302
    s_waitcnt lgkmcnt(0)
    v_perm_b32 v32, v18, v16, s24
    v_perm_b32 v33, v22, v20, s24
    v_perm_b32 v34, v26, v24, s24
    v_perm_b32 v35, v30, v28, s24
    buffer_store_dwordx4 v[32:35], v8, s[12:15], 0 offen offset:0 sc1
    v_perm_b32 v36, v18, v16, s25
    v_perm_b32 v37, v22, v20, s25
    v_perm_b32 v38, v26, v24, s25
    v_perm_b32 v39, v30, v28, s25
    buffer_store_dwordx4 v[36:39], v8, s[12:15], 0 offen offset:1280 sc1
    v_perm_b32 v40, v19, v17, s24
    v_perm_b32 v41, v23, v21, s24
    v_perm_b32 v42, v27, v25, s24
    v_perm_b32 v43, v31, v29, s24
    buffer_store_dwordx4 v[40:43], v8, s[12:15], 0 offen offset:2560 sc1
    v_perm_b32 v44, v19, v17, s25
    v_perm_b32 v45, v23, v21, s25
    v_perm_b32 v46, v27, v25, s25
    v_perm_b32 v47, v31, v29, s25
    buffer_store_dwordx4 v[44:47], v8, s[12:15], 0 offen offset:3840 sc1
L_FINISH:
L_END:
    s_endpgm
.section .rodata,"a"
.p2align 6
.amdhsa_kernel gated_mix__ssm_conv_h3__ssm_conv_s4d__prompt_kernel
  .amdhsa_next_free_vgpr 200
  .amdhsa_next_free_sgpr 102
  .amdhsa_accum_offset 200
  .amdhsa_group_segment_fixed_size 0
  .amdhsa_kernarg_size 136
  .amdhsa_user_sgpr_count 2
  .amdhsa_user_sgpr_kernarg_segment_ptr 1
  .amdhsa_system_sgpr_workgroup_id_x 1
  .amdhsa_float_denorm_mode_32 3
.end_amdhsa_kernel
```
